```python
import torch

def _softmax(x, axis=-1):
    return torch.softmax(x, dim=axis)
def _gelu(x):
    return torch.nn.functional.gelu(x, approximate="tanh")
def _silu(x):
    return torch.nn.functional.silu(x)
def _sigmoid(x):
    return torch.sigmoid(x)
def _layernorm(x, axis=-1, eps=1e-5):
    m = x.mean(dim=axis, keepdim=True)
    v = x.var(dim=axis, keepdim=True, unbiased=False)
    return (x - m) / torch.sqrt(v + eps)
def _scatter_add(tgt, idx, src, axis=0):
    return tgt.clone().index_add_(axis, idx, src)
def _segment_sum(src, seg, n):
    out = torch.zeros((n,) + src.shape[1:], dtype=src.dtype)
    return out.index_add_(0, seg, src)
def _pad(x, pw):
    flat = tuple(v for pair in reversed(pw) for v in pair)
    return torch.nn.functional.pad(x, flat)

kernel_name = 'standalone__convnext_block__vision'

def setup_inputs():

    _w = (lambda a: (lambda t: t.to(torch.bfloat16) if t.is_floating_point() else t)(torch.as_tensor(a)))
    H = W = 224
    C = 192
    return {
        "x": _w((lambda *s: torch.randn(*s, dtype=torch.bfloat16) * 0.05)(1, H, W, C)),
        "dw": _w((lambda *s: torch.randn(*s, dtype=torch.bfloat16) * 0.05)(7, 7, C)),
        "w1": _w((lambda *s: torch.randn(*s, dtype=torch.bfloat16) * 0.05)(C, 4 * C)),
        "w2": _w((lambda *s: torch.randn(*s, dtype=torch.bfloat16) * 0.05)(4 * C, C)),
    }

def reference(x, dw, w1, w2):
    B, H, W, C = x.shape
    pad = 3
    xp = _pad(x, ((0,0),(pad,pad),(pad,pad),(0,0)))
    out = torch.zeros_like(x)
    for i in range(7):
        for j in range(7):
            out = out + xp[:, i:i+H, j:j+W, :] * dw[i, j][None, None, None, :]
    h = _layernorm(out, axis=-1)
    return x + _gelu(h @ w1) @ w2
```

```asm
; @launch grid=(240,1,1) block=(256,1,1) lds=160640
.amdgcn_target "amdgcn-amd-amdhsa--gfx950"
.text
.globl standalone__convnext_block__vision_kernel
.p2align 8
.type standalone__convnext_block__vision_kernel,@function
standalone__convnext_block__vision_kernel:
    s_load_dwordx8 s[4:11], s[0:1], 0
    s_load_dwordx4 s[12:15], s[0:1], 32
    s_load_dwordx2 s[80:81], s[0:1], 48
    s_getpc_b64 s[36:37]
L_pc:
    s_cmp_lt_u32 s2, 24
    s_cbranch_scc1 L_helper
    s_lshr_b32 s41, s2, 3
    s_and_b32 s43, s2, 1
    s_mul_i32 s44, s43, 5
    s_add_u32 s44, s41, s44
    s_cmp_ge_u32 s44, 30
    s_cbranch_scc1 L_end
    s_mov_b32 s38, L_code_end-L_pc
    s_mov_b32 s39, 0x20000
    v_lshlrev_b32 v1, 7, v0
    buffer_load_dword v2, v1, s[36:39], 0 offen
    s_sub_u32 s41, s41, 3
    s_bfe_u32 s3, s2, 0x20001
    s_mul_i32 s42, s3, 49
    s_mul_i32 s44, s43, 27
    s_add_u32 s41, s41, s44
    s_add_u32 s42, s42, s41
    s_cmp_ge_u32 s42, 98
    s_cselect_b32 s43, 98, 0
    s_cselect_b32 s44, 7, 0
    s_sub_u32 s42, s42, s43
    s_mul_i32 s43, s42, 147
    s_lshr_b32 s43, s43, 10
    s_mul_i32 s45, s43, 7
    s_sub_u32 s42, s42, s45
    s_add_u32 s42, s42, s44
    s_lshl_b32 s41, s43, 4
    s_lshl_b32 s42, s42, 4
    s_sub_u32 s41, s41, 3
    s_sub_u32 s42, s42, 3
    s_mul_i32 s43, s41, 224
    s_add_u32 s43, s43, s42
    s_mul_i32 s43, s43, 384
    s_mov_b32 s44, 86016
    s_movk_i32 s45, 384
    s_movk_i32 s46, 368
    s_movk_i32 s47, 224
    s_movk_i32 s48, -22
    v_lshrrev_b32 v3, 6, v0
    v_and_b32 v12, 7, v0
    v_readfirstlane_b32 s40, v3
    v_lshl_add_u32 v13, v12, 4, s43
    v_mul_u32_u24 v12, 8080, v12
    v_lshrrev_b32 v1, 3, v0
    v_mov_b32 v63, 0x7ff00000
    v_add_u32 v3, 0, v1
    v_mul_u32_u24 v60, 745, v3
    v_lshrrev_b32 v60, 14, v60
    v_mad_i32_i24 v61, v60, s48, v3
    v_add_u32 v62, s42, v61
    v_cmp_gt_u32 vcc, s47, v62
    v_mad_u32_u24 v200, v60, s44, v13
    v_mad_u32_u24 v200, v61, s45, v200
    v_cndmask_b32 v200, v63, v200, vcc
    v_mad_u32_u24 v232, v60, s46, v12
    v_lshl_add_u32 v232, v61, 3, v232
    v_add_u32 v3, 32, v1
    v_mul_u32_u24 v60, 745, v3
    v_lshrrev_b32 v60, 14, v60
    v_mad_i32_i24 v61, v60, s48, v3
    v_add_u32 v62, s42, v61
    v_cmp_gt_u32 vcc, s47, v62
    v_mad_u32_u24 v201, v60, s44, v13
    v_mad_u32_u24 v201, v61, s45, v201
    v_cndmask_b32 v201, v63, v201, vcc
    v_mad_u32_u24 v233, v60, s46, v12
    v_lshl_add_u32 v233, v61, 3, v233
    s_mov_b32 s18, 19267584
    s_mov_b32 s19, 0x20000
    s_mov_b32 s22, 18816
    s_mov_b32 s23, 0x20000
    s_lshl_b32 s49, s40, 5
    v_and_b32 v14, 63, v0
    v_lshrrev_b32 v15, 3, v14
    v_and_b32 v16, 7, v14
    v_max_u32 v62, v15, v16
    v_cmp_gt_u32 vcc, 7, v62
    v_mad_u32_u24 v17, v15, 7, v16
    v_mul_u32_u24 v17, 384, v17
    v_cndmask_b32 v17, v63, v17, vcc
    s_waitcnt lgkmcnt(0)
    s_mov_b32 s16, s4
    s_mov_b32 s17, s5
    buffer_load_dwordx4 a[0:3], v200, s[16:19], 0 offen offset:0
    s_mov_b32 s20, s6
    s_mov_b32 s21, s7
    buffer_load_dwordx4 a[4:7], v201, s[16:19], 0 offen offset:0
    buffer_load_dwordx4 v[192:195], v17, s[20:23], s49 offen offset:0
    buffer_load_dwordx4 v[196:199], v17, s[20:23], s49 offen offset:16
    v_add_u32 v3, 64, v1
    v_mul_u32_u24 v60, 745, v3
    v_lshrrev_b32 v60, 14, v60
    v_mad_i32_i24 v61, v60, s48, v3
    v_add_u32 v62, s42, v61
    v_cmp_gt_u32 vcc, s47, v62
    v_mad_u32_u24 v202, v60, s44, v13
    v_mad_u32_u24 v202, v61, s45, v202
    v_cndmask_b32 v202, v63, v202, vcc
    v_mad_u32_u24 v234, v60, s46, v12
    v_lshl_add_u32 v234, v61, 3, v234
    buffer_load_dwordx4 a[8:11], v202, s[16:19], 0 offen offset:0
    v_add_u32 v3, 96, v1
    v_mul_u32_u24 v60, 745, v3
    v_lshrrev_b32 v60, 14, v60
    v_mad_i32_i24 v61, v60, s48, v3
    v_add_u32 v62, s42, v61
    v_cmp_gt_u32 vcc, s47, v62
    v_mad_u32_u24 v203, v60, s44, v13
    v_mad_u32_u24 v203, v61, s45, v203
    v_cndmask_b32 v203, v63, v203, vcc
    v_mad_u32_u24 v235, v60, s46, v12
    v_lshl_add_u32 v235, v61, 3, v235
    buffer_load_dwordx4 a[12:15], v203, s[16:19], 0 offen offset:0
    v_add_u32 v3, 128, v1
    v_mul_u32_u24 v60, 745, v3
    v_lshrrev_b32 v60, 14, v60
    v_mad_i32_i24 v61, v60, s48, v3
    v_add_u32 v62, s42, v61
    v_cmp_gt_u32 vcc, s47, v62
    v_mad_u32_u24 v204, v60, s44, v13
    v_mad_u32_u24 v204, v61, s45, v204
    v_cndmask_b32 v204, v63, v204, vcc
    v_mad_u32_u24 v236, v60, s46, v12
    v_lshl_add_u32 v236, v61, 3, v236
    buffer_load_dwordx4 a[16:19], v204, s[16:19], 0 offen offset:0
    v_add_u32 v3, 160, v1
    v_mul_u32_u24 v60, 745, v3
    v_lshrrev_b32 v60, 14, v60
    v_mad_i32_i24 v61, v60, s48, v3
    v_add_u32 v62, s42, v61
    v_cmp_gt_u32 vcc, s47, v62
    v_mad_u32_u24 v205, v60, s44, v13
    v_mad_u32_u24 v205, v61, s45, v205
    v_cndmask_b32 v205, v63, v205, vcc
    v_mad_u32_u24 v237, v60, s46, v12
    v_lshl_add_u32 v237, v61, 3, v237
    buffer_load_dwordx4 a[20:23], v205, s[16:19], 0 offen offset:0
    v_add_u32 v3, 192, v1
    v_mul_u32_u24 v60, 745, v3
    v_lshrrev_b32 v60, 14, v60
    v_mad_i32_i24 v61, v60, s48, v3
    v_add_u32 v62, s42, v61
    v_cmp_gt_u32 vcc, s47, v62
    v_mad_u32_u24 v206, v60, s44, v13
    v_mad_u32_u24 v206, v61, s45, v206
    v_cndmask_b32 v206, v63, v206, vcc
    v_mad_u32_u24 v238, v60, s46, v12
    v_lshl_add_u32 v238, v61, 3, v238
    buffer_load_dwordx4 a[24:27], v206, s[16:19], 0 offen offset:0
    v_add_u32 v3, 224, v1
    v_mul_u32_u24 v60, 745, v3
    v_lshrrev_b32 v60, 14, v60
    v_mad_i32_i24 v61, v60, s48, v3
    v_add_u32 v62, s42, v61
    v_cmp_gt_u32 vcc, s47, v62
    v_mad_u32_u24 v207, v60, s44, v13
    v_mad_u32_u24 v207, v61, s45, v207
    v_cndmask_b32 v207, v63, v207, vcc
    v_mad_u32_u24 v239, v60, s46, v12
    v_lshl_add_u32 v239, v61, 3, v239
    buffer_load_dwordx4 a[28:31], v207, s[16:19], 0 offen offset:0
    v_add_u32 v3, 256, v1
    v_mul_u32_u24 v60, 745, v3
    v_lshrrev_b32 v60, 14, v60
    v_mad_i32_i24 v61, v60, s48, v3
    v_add_u32 v62, s42, v61
    v_cmp_gt_u32 vcc, s47, v62
    v_mad_u32_u24 v208, v60, s44, v13
    v_mad_u32_u24 v208, v61, s45, v208
    v_cndmask_b32 v208, v63, v208, vcc
    v_mad_u32_u24 v240, v60, s46, v12
    v_lshl_add_u32 v240, v61, 3, v240
    buffer_load_dwordx4 a[32:35], v208, s[16:19], 0 offen offset:0
    v_add_u32 v3, 288, v1
    v_mul_u32_u24 v60, 745, v3
    v_lshrrev_b32 v60, 14, v60
    v_mad_i32_i24 v61, v60, s48, v3
    v_add_u32 v62, s42, v61
    v_cmp_gt_u32 vcc, s47, v62
    v_mad_u32_u24 v209, v60, s44, v13
    v_mad_u32_u24 v209, v61, s45, v209
    v_cndmask_b32 v209, v63, v209, vcc
    v_mad_u32_u24 v241, v60, s46, v12
    v_lshl_add_u32 v241, v61, 3, v241
    v_add_u32 v3, 320, v1
    v_mul_u32_u24 v60, 745, v3
    v_lshrrev_b32 v60, 14, v60
    v_mad_i32_i24 v61, v60, s48, v3
    v_add_u32 v62, s42, v61
    v_cmp_gt_u32 vcc, s47, v62
    v_mad_u32_u24 v210, v60, s44, v13
    v_mad_u32_u24 v210, v61, s45, v210
    v_cndmask_b32 v210, v63, v210, vcc
    v_mad_u32_u24 v242, v60, s46, v12
    v_lshl_add_u32 v242, v61, 3, v242
    v_add_u32 v3, 352, v1
    v_mul_u32_u24 v60, 745, v3
    v_lshrrev_b32 v60, 14, v60
    v_mad_i32_i24 v61, v60, s48, v3
    v_add_u32 v62, s42, v61
    v_cmp_gt_u32 vcc, s47, v62
    v_mad_u32_u24 v211, v60, s44, v13
    v_mad_u32_u24 v211, v61, s45, v211
    v_cndmask_b32 v211, v63, v211, vcc
    v_mad_u32_u24 v243, v60, s46, v12
    v_lshl_add_u32 v243, v61, 3, v243
    v_add_u32 v3, 384, v1
    v_mul_u32_u24 v60, 745, v3
    v_lshrrev_b32 v60, 14, v60
    v_mad_i32_i24 v61, v60, s48, v3
    v_add_u32 v62, s42, v61
    v_cmp_gt_u32 vcc, s47, v62
    v_mad_u32_u24 v212, v60, s44, v13
    v_mad_u32_u24 v212, v61, s45, v212
    v_cndmask_b32 v212, v63, v212, vcc
    v_mad_u32_u24 v244, v60, s46, v12
    v_lshl_add_u32 v244, v61, 3, v244
    v_add_u32 v3, 416, v1
    v_mul_u32_u24 v60, 745, v3
    v_lshrrev_b32 v60, 14, v60
    v_mad_i32_i24 v61, v60, s48, v3
    v_add_u32 v62, s42, v61
    v_cmp_gt_u32 vcc, s47, v62
    v_mad_u32_u24 v213, v60, s44, v13
    v_mad_u32_u24 v213, v61, s45, v213
    v_cndmask_b32 v213, v63, v213, vcc
    v_mad_u32_u24 v245, v60, s46, v12
    v_lshl_add_u32 v245, v61, 3, v245
    v_add_u32 v3, 448, v1
    v_mul_u32_u24 v60, 745, v3
    v_lshrrev_b32 v60, 14, v60
    v_mad_i32_i24 v61, v60, s48, v3
    v_add_u32 v62, s42, v61
    v_cmp_gt_u32 vcc, s47, v62
    v_mad_u32_u24 v214, v60, s44, v13
    v_mad_u32_u24 v214, v61, s45, v214
    v_cndmask_b32 v214, v63, v214, vcc
    v_mad_u32_u24 v246, v60, s46, v12
    v_lshl_add_u32 v246, v61, 3, v246
    v_add_u32 v3, 480, v1
    v_mul_u32_u24 v60, 745, v3
    v_lshrrev_b32 v60, 14, v60
    v_mad_i32_i24 v61, v60, s48, v3
    v_add_u32 v62, s42, v61
    v_cmp_gt_u32 vcc, s47, v62
    v_mad_u32_u24 v215, v60, s44, v13
    v_mad_u32_u24 v215, v61, s45, v215
    v_cndmask_b32 v215, v63, v215, vcc
    v_mad_u32_u24 v247, v60, s46, v12
    v_lshl_add_u32 v247, v61, 3, v247
    v_cmp_gt_u32 vcc, 4, v1
    v_and_b32 v60, 15, v0
    v_lshlrev_b32 v60, 3, v60
    v_add_u32 v60, 64640, v60
    v_cndmask_b32 v215, v63, v215, vcc
    v_cndmask_b32 v247, v60, v247, vcc
    v_mov_b32 v3, v14
    s_mul_i32 s50, s40, 7680
    s_add_u32 s50, s50, 64960
    s_add_u32 s51, s50, 32
    v_lshl_add_u32 v22, v3, 2, s51
    v_mov_b32 v42, 0
    v_mov_b32 v43, 0
    v_mov_b32 v44, 0
    v_mov_b32 v45, 0
    v_lshl_add_u32 v60, v3, 4, s50
    ds_write_b128 v60, v[42:45] offset:0
    ds_write_b128 v60, v[42:45] offset:1024
    ds_write_b128 v60, v[42:45] offset:2048
    ds_write_b128 v60, v[42:45] offset:3072
    ds_write_b128 v60, v[42:45] offset:4096
    ds_write_b128 v60, v[42:45] offset:5120
    ds_write_b128 v60, v[42:45] offset:6144
    ds_write_b128 v60, v[42:45] offset:6656
    s_mov_b32 s24, s8
    s_mov_b32 s25, s9
    s_mov_b32 s26, 294912
    s_mov_b32 s27, 0x20000
    s_mov_b32 s84, s80
    s_mov_b32 s85, s81
    s_mov_b32 s86, 2097152
    s_mov_b32 s87, 0x20000
    s_mov_b32 s88, s14
    s_mov_b32 s89, s15
    s_mov_b32 s90, 256
    s_mov_b32 s91, 0x20000
    s_mov_b32 s32, s12
    s_mov_b32 s33, s13
    s_mov_b32 s34, 19267584
    s_mov_b32 s35, 0x20000
    s_mov_b32 s60, 0x44e944e9
    s_mov_b32 s61, 0xbef00000
    s_mov_b32 s59, 0xb780b780
    s_mov_b32 s69, 95680
    v_and_b32 v60, 7, v3
    v_bfe_u32 v61, v3, 3, 1
    v_lshrrev_b32 v62, 4, v3
    v_add_u32 v60, v60, v62
    v_mul_u32_u24 v61, 2944, v61
    v_lshl_add_u32 v20, v60, 4, v61
    s_mul_i32 s51, s40, 16160
    v_add_u32 v20, s51, v20
    v_and_b32 v60, 3, v3
    v_mul_u32_u24 v46, 0x5555, v60
    v_mad_u32_u24 v60, v60, 20, v62
    v_bfe_u32 v61, v3, 2, 1
    v_mul_u32_u24 v61, 80, v61
    v_add_u32 v60, v60, v61
    v_bfe_u32 v61, v3, 3, 1
    v_xor_b32 v61, 1, v61
    v_lshl_add_u32 v60, v61, 1, v60
    v_lshl_add_u32 v21, v60, 4, s50
    buffer_load_dwordx4 a[36:39], v209, s[16:19], 0 offen offset:0
    buffer_load_dwordx4 a[40:43], v210, s[16:19], 0 offen offset:0
    s_waitcnt vmcnt(12)
    ds_write2_b64 v232, a[0:1], a[2:3] offset0:0 offset1:22
    buffer_load_dwordx4 a[44:47], v211, s[16:19], 0 offen offset:0
    v_add_u32 v232, s69, v232
    s_waitcnt vmcnt(11)
    ds_write_b16 v22, v192 offset:0
    ds_write_b16_d16_hi v22, v192 offset:320
    ds_write_b16 v22, v193 offset:640
    v_bfe_u32 v60, v3, 3, 1
    v_lshlrev_b32 v60, 3, v60
    s_lshl_b32 s52, s40, 1
    v_add_u32 v60, s52, v60
    ds_write_b16_d16_hi v22, v193 offset:960
    ds_write2_b64 v233, a[4:5], a[6:7] offset0:0 offset1:22
    buffer_load_dwordx4 a[48:51], v212, s[16:19], 0 offen offset:0
    v_add_u32 v233, s69, v233
    ds_write_b16 v22, v192 offset:1284
    ds_write_b16_d16_hi v22, v192 offset:1604
    v_and_b32 v61, 7, v3
    v_bfe_u32 v62, v3, 4, 1
    v_lshl_add_u32 v61, v61, 1, v62
    v_lshrrev_b32 v62, 5, v3
    ds_write_b16 v22, v193 offset:1924
    ds_write_b16_d16_hi v22, v193 offset:2244
    s_waitcnt vmcnt(10)
    ds_write2_b64 v234, a[8:9], a[10:11] offset0:0 offset1:22
    buffer_load_dwordx4 a[52:55], v213, s[16:19], 0 offen offset:0
    v_add_u32 v234, s69, v234
    ds_read_b128 a[192:195], v21 offset:0
    v_mul_u32_u24 v24, 8080, v62
    v_mad_u32_u24 v24, v60, s46, v24
    v_lshl_add_u32 v24, v61, 3, v24
    v_add_u32 v24, 1128, v24
    ds_read_b128 a[196:199], v21 offset:64
    ds_read_b128 a[200:203], v21 offset:128
    ds_read_b128 a[204:207], v21 offset:192
    s_waitcnt vmcnt(10)
    ds_write2_b64 v235, a[12:13], a[14:15] offset0:0 offset1:22
    buffer_load_dwordx4 a[56:59], v214, s[16:19], 0 offen offset:0
    v_add_u32 v235, s69, v235
    v_bfe_u32 v60, v3, 2, 1
    v_cmp_eq_u32 vcc, v60, v62
    v_and_b32 v61, 1, v3
    v_lshlrev_b32 v61, 4, v61
    ds_write_b16 v22, v194 offset:2560
    ds_write_b16_d16_hi v22, v194 offset:2880
    ds_write_b16 v22, v195 offset:3200
    v_mov_b32 v60, 0x3f80
    s_waitcnt vmcnt(10)
    ds_write2_b64 v236, a[16:17], a[18:19] offset0:0 offset1:22
    buffer_load_dwordx4 a[60:63], v215, s[16:19], 0 offen offset:0
    v_add_u32 v236, s69, v236
    v_lshlrev_b32 v60, v61, v60
    v_cndmask_b32 v60, 0, v60, vcc
    v_bfe_u32 v61, v3, 1, 1
    ds_write_b16_d16_hi v22, v195 offset:3520
    ds_write_b16 v22, v194 offset:3844
    ds_write_b16_d16_hi v22, v194 offset:4164
    v_bfe_u32 v62, v3, 3, 2
    v_lshl_add_u32 v61, v62, 1, v61
    buffer_load_dwordx4 v[216:219], v17, s[20:23], s49 offen offset:128
    s_waitcnt vmcnt(11)
    ds_write2_b64 v237, a[20:21], a[22:23] offset0:0 offset1:22
    buffer_load_dwordx4 a[64:67], v200, s[16:19], 0 offen offset:128
    v_add_u32 v237, s69, v237
    v_cmp_eq_u32 vcc, 0, v61
    v_cmp_eq_u32 s[54:55], 1, v61
    ds_write_b16 v22, v195 offset:4484
    ds_write_b16_d16_hi v22, v195 offset:4804
    ds_read_b128 v[144:147], v21 offset:2560
    s_nop 0
    v_cndmask_b32 v34, 0, v60, vcc
    v_cndmask_b32 v35, 0, v60, s[54:55]
    s_waitcnt vmcnt(11)
    ds_write2_b64 v238, a[24:25], a[26:27] offset0:0 offset1:22
    buffer_load_dwordx4 a[68:71], v201, s[16:19], 0 offen offset:128
    v_add_u32 v238, s69, v238
    v_cmp_eq_u32 vcc, 2, v61
    ds_read_b128 v[148:151], v21 offset:2624
    ds_read_b128 v[152:155], v21 offset:2688
    ds_read_b128 v[156:159], v21 offset:2752
    v_cmp_eq_u32 s[54:55], 3, v61
    s_nop 0
    v_cndmask_b32 v36, 0, v60, vcc
    v_cndmask_b32 v37, 0, v60, s[54:55]
    buffer_load_dwordx4 v[220:223], v17, s[20:23], s49 offen offset:144
    s_waitcnt vmcnt(12)
    ds_write2_b64 v239, a[28:29], a[30:31] offset0:0 offset1:22
    buffer_load_dwordx4 a[72:75], v202, s[16:19], 0 offen offset:128
    v_add_u32 v239, s69, v239
    ds_write_b16 v22, v196 offset:5120
    ds_write_b16_d16_hi v22, v196 offset:5440
    ds_write_b16 v22, v197 offset:5760
    v_cmp_eq_u32 vcc, 4, v61
    v_cmp_eq_u32 s[54:55], 5, v61
    s_nop 0
    v_cndmask_b32 v38, 0, v60, vcc
    ds_write_b16_d16_hi v22, v197 offset:6080
    s_waitcnt vmcnt(12)
    ds_write2_b64 v240, a[32:33], a[34:35] offset0:0 offset1:22
    buffer_load_dwordx4 a[76:79], v203, s[16:19], 0 offen offset:128
    v_add_u32 v240, s69, v240
    ds_write_b16 v22, v196 offset:6404
    ds_write_b16_d16_hi v22, v196 offset:6724
    v_cndmask_b32 v39, 0, v60, s[54:55]
    v_cmp_eq_u32 vcc, 6, v61
    v_cmp_eq_u32 s[54:55], 7, v61
    s_nop 0
    ds_write_b16 v22, v197 offset:7044
    ds_write_b16_d16_hi v22, v197 offset:7364
    s_waitcnt vmcnt(12)
    ds_write2_b64 v241, a[36:37], a[38:39] offset0:0 offset1:22
    buffer_load_dwordx4 a[80:83], v204, s[16:19], 0 offen offset:128
    v_add_u32 v241, s69, v241
    ds_read_b128 v[160:163], v21 offset:5120
    v_cndmask_b32 v40, 0, v60, vcc
    v_cndmask_b32 v41, 0, v60, s[54:55]
    v_mov_b32 v26, 0
    v_mov_b32 v27, 0
    ds_read_b128 v[164:167], v21 offset:5184
    ds_read_b128 v[168:171], v21 offset:5248
    ds_read_b128 v[172:175], v21 offset:5312
    s_waitcnt vmcnt(12)
    ds_write2_b64 v242, a[40:41], a[42:43] offset0:0 offset1:22
    buffer_load_dwordx4 a[84:87], v205, s[16:19], 0 offen offset:128
    v_add_u32 v242, s69, v242
    v_mov_b32 v28, 0
    v_mov_b32 v29, 0
    v_mov_b32 v30, 0
    v_mov_b32 v31, 0
    ds_write_b16 v22, v198 offset:0
    ds_write_b16_d16_hi v22, v198 offset:320
    ds_write_b16 v22, v199 offset:640
    v_mov_b32 v32, 0
    s_waitcnt vmcnt(12)
    ds_write2_b64 v243, a[44:45], a[46:47] offset0:0 offset1:22
    buffer_load_dwordx4 a[88:91], v206, s[16:19], 0 offen offset:128
    v_add_u32 v243, s69, v243
    v_mov_b32 v33, 0
    ds_write_b16_d16_hi v22, v199 offset:960
    ds_write_b16 v22, v198 offset:1284
    ds_write_b16_d16_hi v22, v198 offset:1604
    ds_write_b16 v22, v199 offset:1924
    ds_write_b16_d16_hi v22, v199 offset:2244
    ds_read_b128 v[176:179], v21 offset:0
    ds_read_b128 v[180:183], v21 offset:64
    s_waitcnt vmcnt(12)
    ds_write2_b64 v244, a[48:49], a[50:51] offset0:0 offset1:22
    buffer_load_dwordx4 a[92:95], v207, s[16:19], 0 offen offset:128
    v_add_u32 v244, s69, v244
    ds_read_b128 v[184:187], v21 offset:128
    ds_read_b128 v[188:191], v21 offset:192
    v_mfma_f32_32x32x16_bf16 v[64:79], v[42:45], v[42:45], 0
    v_and_b32 v3, 63, v0
    v_lshrrev_b32 v12, 5, v3
    v_bfe_u32 v13, v3, 2, 2
    v_lshl_add_u32 v14, v12, 3, v13
    v_lshlrev_b32 v14, 7, v14
    s_waitcnt vmcnt(12)
    ds_write2_b64 v245, a[52:53], a[54:55] offset0:0 offset1:22
    buffer_load_dwordx4 a[96:99], v208, s[16:19], 0 offen offset:128
    v_add_u32 v245, s69, v245
    v_bfe_u32 v2, v3, 4, 1
    v_lshl_add_u32 v14, v2, 5, v14
    v_and_b32 v2, 3, v3
    v_lshl_add_u32 v14, v2, 3, v14
    v_bfe_u32 v2, v3, 3, 1
    v_lshl_add_u32 v50, v2, 6, v14
    v_lshrrev_b32 v12, 3, v3
    v_mul_u32_u24 v12, 1536, v12
    s_waitcnt vmcnt(12)
    ds_write2_b64 v246, a[56:57], a[58:59] offset0:0 offset1:22
    buffer_load_dwordx4 a[100:103], v209, s[16:19], 0 offen offset:128
    v_add_u32 v246, s69, v246
    v_and_b32 v13, 7, v3
    v_bfe_u32 v14, v3, 4, 1
    v_lshlrev_b32 v14, 2, v14
    v_xor_b32 v13, v13, v14
    v_lshl_add_u32 v56, v13, 4, v12
    v_add_u32 v57, 11264, v56
    v_add_u32 v58, 22528, v56
    v_lshlrev_b32 v59, 4, v3
    s_waitcnt vmcnt(12)
    ds_write2_b64 v247, a[60:61], a[62:63] offset0:0 offset1:22
    buffer_load_dwordx4 a[104:107], v210, s[16:19], 0 offen offset:128
    v_add_u32 v247, s69, v247
    v_xor_b32 v51, 64, v50
    v_add_u32 v50, 98304, v50
    v_add_u32 v51, 98304, v51
    v_add_u32 v52, 122880, v59
    v_add_u32 v53, 24576, v59
    s_mul_i32 s64, s40, 73728
    s_add_u32 s65, s64, 36864
    s_mul_i32 s63, s40, 6144
    s_waitcnt lgkmcnt(0)
    s_barrier
    ds_read_b128 a[208:211], v20 offset:0
    ds_read_b128 a[212:215], v20 offset:368
    ds_read_b128 a[216:219], v20 offset:736
    ds_read_b128 a[220:223], v20 offset:1104
    ds_read_b128 a[224:227], v20 offset:1472
    ds_read_b128 a[228:231], v20 offset:1840
    ds_read_b128 a[232:235], v20 offset:2208
    ds_read_b128 a[236:239], v20 offset:2576
    s_mov_b32 s62, -24576
    s_mul_i32 s52, s40, 24576
    s_add_u32 s52, s52, 24576
    v_and_b32 v12, 31, v3
    v_lshrrev_b32 v13, 5, v3
    v_and_b32 v14, 7, v3
    v_xor_b32 v13, v13, v14
    v_lshlrev_b32 v13, 4, v13
    v_lshl_add_u32 v13, v12, 7, v13
    v_add_u32 v25, s52, v13
    v_lshrrev_b32 v12, 3, v3
    v_xor_b32 v13, v12, v14
    v_lshlrev_b32 v13, 4, v13
    v_lshl_add_u32 v13, v12, 7, v13
    v_add_u32 v63, s52, v13
    s_lshl_b32 s52, s40, 1
    s_waitcnt lgkmcnt(6)
    v_smfmac_f32_16x16x64_bf16 v[64:67], a[192:195], a[208:215], v46
    ds_read_b128 a[240:243], v20 offset:2944
    ds_read_b128 a[244:247], v20 offset:3312
    s_mul_i32 s52, s52, 86016
    s_add_u32 s53, s43, 259200
    v_mfma_f32_32x32x16_bf16 v[80:95], v[42:45], v[42:45], 0
    s_waitcnt lgkmcnt(6)
    s_waitcnt vmcnt(11)
    ds_write2_b64 v232, a[64:65], a[66:67] offset0:0 offset1:22
    buffer_load_dwordx4 a[108:111], v211, s[16:19], 0 offen offset:128
    v_subrev_u32 v232, s69, v232
    s_add_u32 s53, s53, s52
    v_mul_u32_u24 v12, 768, v12
    v_lshl_add_u32 v12, v14, 4, v12
    v_smfmac_f32_16x16x64_bf16 v[64:67], a[196:199], a[216:223], v46
    ds_read_b128 a[248:251], v20 offset:3680
    ds_read_b128 a[252:255], v20 offset:4048
    v_add_u32 v62, s53, v12
    v_smfmac_f32_16x16x64_bf16 v[68:71], a[192:195], a[216:223], v46
    s_waitcnt lgkmcnt(7)
    ds_read_b128 a[208:211], v20 offset:4416
    ds_read_b128 a[212:215], v20 offset:4784
    v_smfmac_f32_16x16x64_bf16 v[64:67], a[200:203], a[224:231], v46
    ds_read_b64 v[4:5], v24 offset:0
    ds_read_b64 v[6:7], v24 offset:176
    v_smfmac_f32_16x16x64_bf16 v[68:71], a[196:199], a[224:231], v46
    s_waitcnt vmcnt(11)
    ds_write2_b64 v233, a[68:69], a[70:71] offset0:0 offset1:22
    buffer_load_dwordx4 a[112:115], v212, s[16:19], 0 offen offset:128
    v_subrev_u32 v233, s69, v233
    v_smfmac_f32_16x16x64_bf16 v[72:75], a[192:195], a[224:231], v46
    s_waitcnt lgkmcnt(10)
    ds_read_b128 a[216:219], v20 offset:176
    ds_read_b128 a[220:223], v20 offset:544
    v_smfmac_f32_16x16x64_bf16 v[64:67], a[204:207], a[232:239], v46
    ds_read_b64 v[8:9], v24 offset:16160
    ds_read_b64 v[10:11], v24 offset:16336
    v_smfmac_f32_16x16x64_bf16 v[68:71], a[200:203], a[232:239], v46
    ds_read_b128 a[224:227], v20 offset:912
    ds_read_b128 a[228:231], v20 offset:1280
    v_smfmac_f32_16x16x64_bf16 v[72:75], a[196:199], a[232:239], v46
    ds_write_b16 v22, v216 offset:2560
    ds_write_b16_d16_hi v22, v216 offset:2880
    v_add_f32 v26, v26, v64
    v_fmac_f32 v27, v64, v64
    v_smfmac_f32_16x16x64_bf16 v[76:79], a[192:195], a[232:239], v46
    s_waitcnt lgkmcnt(15)
    s_waitcnt vmcnt(10)
    ds_write2_b64 v234, a[72:73], a[74:75] offset0:0 offset1:22
    buffer_load_dwordx4 a[116:119], v213, s[16:19], 0 offen offset:128
    v_subrev_u32 v234, s69, v234
    v_add_f32 v26, v26, v65
    v_fmac_f32 v27, v65, v65
    v_smfmac_f32_16x16x64_bf16 v[68:71], a[204:207], a[240:247], v46
    ds_read_b128 a[232:235], v20 offset:1648
    ds_read_b128 a[236:239], v20 offset:2016
    v_add_f32 v26, v26, v66
    v_fmac_f32 v27, v66, v66
    v_smfmac_f32_16x16x64_bf16 v[72:75], a[200:203], a[240:247], v46
    ds_write_b16 v22, v217 offset:3200
    ds_write_b16_d16_hi v22, v217 offset:3520
    v_add_f32 v26, v26, v67
    v_fmac_f32 v27, v67, v67
    v_smfmac_f32_16x16x64_bf16 v[76:79], a[196:199], a[240:247], v46
    s_waitcnt lgkmcnt(15)
    ds_read_b128 a[240:243], v20 offset:2384
    ds_read_b128 a[244:247], v20 offset:2752
    v_add_f32 v28, v28, v68
    v_fmac_f32 v29, v68, v68
    v_smfmac_f32_16x16x64_bf16 v[72:75], a[204:207], a[248:255], v46
    ds_write_b16 v22, v216 offset:3844
    ds_write_b16_d16_hi v22, v216 offset:4164
    v_add_f32 v28, v28, v69
    v_fmac_f32 v29, v69, v69
    v_smfmac_f32_16x16x64_bf16 v[76:79], a[200:203], a[248:255], v46
    s_waitcnt lgkmcnt(15)
    s_waitcnt vmcnt(10)
    ds_write2_b64 v235, a[76:77], a[78:79] offset0:0 offset1:22
    buffer_load_dwordx4 a[120:123], v214, s[16:19], 0 offen offset:128
    v_subrev_u32 v235, s69, v235
    v_add_f32 v28, v28, v70
    v_fmac_f32 v29, v70, v70
    v_mfma_f32_32x32x16_bf16 a[0:15], v[34:37], v[4:7], 0
    ds_read_b128 a[248:251], v20 offset:3120
    ds_read_b128 a[252:255], v20 offset:3488
    ds_read_b64 v[4:5], v24 offset:368
    v_add_f32 v28, v28, v71
    v_fmac_f32 v29, v71, v71
    v_add_f32 v30, v30, v72
    v_smfmac_f32_16x16x64_bf16 v[76:79], a[204:207], a[208:215], v46
    s_waitcnt lgkmcnt(15)
    ds_read_b128 a[208:211], v20 offset:3856
    ds_read_b128 a[212:215], v20 offset:4224
    v_fmac_f32 v31, v72, v72
    v_add_f32 v30, v30, v73
    v_mfma_f32_32x32x16_bf16 a[0:15], v[38:41], v[8:11], a[0:15]
    ds_read_b64 v[6:7], v24 offset:544
    ds_read_b64 v[8:9], v24 offset:16528
    ds_read_b64 v[10:11], v24 offset:16704
    v_fmac_f32 v31, v73, v73
    v_add_f32 v30, v30, v74
    v_fmac_f32 v31, v74, v74
    v_smfmac_f32_16x16x64_bf16 v[80:83], v[144:147], a[216:223], v46
    ds_read_b128 a[216:219], v20 offset:4592
    ds_read_b128 a[220:223], v20 offset:4960
    v_add_f32 v30, v30, v75
    v_fmac_f32 v31, v75, v75
    v_mfma_f32_32x32x16_bf16 v[96:111], v[42:45], v[42:45], 0
    s_waitcnt vmcnt(10)
    ds_write2_b64 v236, a[80:81], a[82:83] offset0:0 offset1:22
    buffer_load_dwordx4 a[124:127], v215, s[16:19], 0 offen offset:128
    v_subrev_u32 v236, s69, v236
    buffer_load_dwordx4 v[248:251], v17, s[20:23], s49 offen offset:256
    v_add_f32 v32, v32, v76
    v_fmac_f32 v33, v76, v76
    v_add_f32 v32, v32, v77
    v_smfmac_f32_16x16x64_bf16 v[80:83], v[148:151], a[224:231], v46
    ds_write_b16 v22, v217 offset:4484
    ds_write_b16_d16_hi v22, v217 offset:4804
    v_fmac_f32 v33, v77, v77
    v_add_f32 v32, v32, v78
    v_smfmac_f32_16x16x64_bf16 v[84:87], v[144:147], a[224:231], v46
    s_waitcnt lgkmcnt(15)
    ds_read_b128 a[224:227], v20 offset:8080
    ds_read_b128 a[228:231], v20 offset:8448
    v_fmac_f32 v33, v78, v78
    v_add_f32 v32, v32, v79
    v_smfmac_f32_16x16x64_bf16 v[80:83], v[152:155], a[232:239], v46
    ds_write_b16 v22, v218 offset:5120
    ds_write_b16_d16_hi v22, v218 offset:5440
    v_fmac_f32 v33, v79, v79
    v_smfmac_f32_16x16x64_bf16 v[84:87], v[148:151], a[232:239], v46
    s_waitcnt vmcnt(11)
    ds_write2_b64 v237, a[84:85], a[86:87] offset0:0 offset1:22
    buffer_load_dwordx4 a[128:131], v200, s[16:19], 0 offen offset:256
    v_subrev_u32 v237, s69, v237
    v_smfmac_f32_16x16x64_bf16 v[88:91], v[144:147], a[232:239], v46
    ds_read_b128 a[232:235], v20 offset:8816
    ds_read_b128 a[236:239], v20 offset:9184
    v_smfmac_f32_16x16x64_bf16 v[80:83], v[156:159], a[240:247], v46
    ds_read_b128 a[192:195], v21 offset:2560
    ds_write_b16 v22, v219 offset:5760
    v_smfmac_f32_16x16x64_bf16 v[84:87], v[152:155], a[240:247], v46
    ds_write_b16_d16_hi v22, v219 offset:6080
    ds_read_b128 a[196:199], v21 offset:2624
    v_smfmac_f32_16x16x64_bf16 v[88:91], v[148:151], a[240:247], v46
    ds_write_b16 v22, v218 offset:6404
    ds_write_b16_d16_hi v22, v218 offset:6724
    v_add_f32 v26, v26, v80
    v_fmac_f32 v27, v80, v80
    v_smfmac_f32_16x16x64_bf16 v[92:95], v[144:147], a[240:247], v46
    s_waitcnt lgkmcnt(15)
    s_waitcnt vmcnt(11)
    ds_write2_b64 v238, a[88:89], a[90:91] offset0:0 offset1:22
    buffer_load_dwordx4 a[132:135], v201, s[16:19], 0 offen offset:256
    v_subrev_u32 v238, s69, v238
    buffer_load_dwordx4 v[252:255], v17, s[20:23], s49 offen offset:272
    v_add_f32 v26, v26, v81
    v_fmac_f32 v27, v81, v81
    v_smfmac_f32_16x16x64_bf16 v[84:87], v[156:159], a[248:255], v46
    ds_read_b128 a[240:243], v20 offset:9552
    ds_read_b128 a[244:247], v20 offset:9920
    v_add_f32 v26, v26, v82
    v_fmac_f32 v27, v82, v82
    v_smfmac_f32_16x16x64_bf16 v[88:91], v[152:155], a[248:255], v46
    ds_read_b128 a[200:203], v21 offset:2688
    ds_write_b16 v22, v219 offset:7044
    v_add_f32 v26, v26, v83
    v_fmac_f32 v27, v83, v83
    v_smfmac_f32_16x16x64_bf16 v[92:95], v[148:151], a[248:255], v46
    ds_read_b128 a[248:251], v20 offset:10288
    ds_read_b128 a[252:255], v20 offset:10656
    v_add_f32 v28, v28, v84
    v_fmac_f32 v29, v84, v84
    v_smfmac_f32_16x16x64_bf16 v[88:91], v[156:159], a[208:215], v46
    ds_write_b16_d16_hi v22, v219 offset:7364
    ds_read_b128 a[204:207], v21 offset:2752
    v_add_f32 v28, v28, v85
    v_fmac_f32 v29, v85, v85
    v_smfmac_f32_16x16x64_bf16 v[92:95], v[152:155], a[208:215], v46
    s_waitcnt vmcnt(12)
    ds_write2_b64 v239, a[92:93], a[94:95] offset0:0 offset1:22
    buffer_load_dwordx4 a[136:139], v202, s[16:19], 0 offen offset:256
    v_subrev_u32 v239, s69, v239
    v_add_f32 v28, v28, v86
    v_fmac_f32 v29, v86, v86
    v_mfma_f32_32x32x16_bf16 a[16:31], v[34:37], v[4:7], 0
    ds_read_b128 a[208:211], v20 offset:11024
    ds_read_b128 a[212:215], v20 offset:11392
    ds_read_b64 v[4:5], v24 offset:32320
    v_add_f32 v28, v28, v87
    v_fmac_f32 v29, v87, v87
    v_add_f32 v30, v30, v88
    v_smfmac_f32_16x16x64_bf16 v[92:95], v[156:159], a[216:223], v46
    ds_read_b128 a[216:219], v20 offset:11760
    ds_read_b128 a[220:223], v20 offset:12128
    v_fmac_f32 v31, v88, v88
    v_add_f32 v30, v30, v89
    v_mfma_f32_32x32x16_bf16 a[16:31], v[38:41], v[8:11], a[16:31]
    s_waitcnt lgkmcnt(15)
    ds_read_b64 v[6:7], v24 offset:32496
    ds_read_b64 v[8:9], v24 offset:48480
    ds_read_b64 v[10:11], v24 offset:48656
    v_fmac_f32 v31, v89, v89
    v_add_f32 v30, v30, v90
    v_fmac_f32 v31, v90, v90
    v_smfmac_f32_16x16x64_bf16 v[96:99], v[160:163], a[224:231], v46
    ds_read_b128 a[224:227], v20 offset:12496
    ds_read_b128 a[228:231], v20 offset:12864
    v_add_f32 v30, v30, v91
    v_fmac_f32 v31, v91, v91
    v_mfma_f32_32x32x16_bf16 v[112:127], v[42:45], v[42:45], 0
    s_waitcnt vmcnt(12)
    ds_write2_b64 v240, a[96:97], a[98:99] offset0:0 offset1:22
    buffer_load_dwordx4 a[140:143], v203, s[16:19], 0 offen offset:256
    v_subrev_u32 v240, s69, v240
    v_add_f32 v32, v32, v92
    v_fmac_f32 v33, v92, v92
    v_add_f32 v32, v32, v93
    v_smfmac_f32_16x16x64_bf16 v[96:99], v[164:167], a[232:239], v46
    ds_write_b16 v22, v220 offset:0
    ds_write_b16_d16_hi v22, v220 offset:320
    v_fmac_f32 v33, v93, v93
    v_add_f32 v32, v32, v94
    v_smfmac_f32_16x16x64_bf16 v[100:103], v[160:163], a[232:239], v46
    s_waitcnt lgkmcnt(15)
    ds_read_b128 a[232:235], v20 offset:8256
    ds_read_b128 a[236:239], v20 offset:8624
    v_fmac_f32 v33, v94, v94
    v_add_f32 v32, v32, v95
    v_smfmac_f32_16x16x64_bf16 v[96:99], v[168:171], a[240:247], v46
    ds_write_b16 v22, v221 offset:640
    ds_write_b16_d16_hi v22, v221 offset:960
    v_fmac_f32 v33, v95, v95
    v_smfmac_f32_16x16x64_bf16 v[100:103], v[164:167], a[240:247], v46
    s_waitcnt vmcnt(12)
    ds_write2_b64 v241, a[100:101], a[102:103] offset0:0 offset1:22
    buffer_load_dwordx4 a[144:147], v204, s[16:19], 0 offen offset:256
    v_subrev_u32 v241, s69, v241
    v_smfmac_f32_16x16x64_bf16 v[104:107], v[160:163], a[240:247], v46
    ds_read_b128 a[240:243], v20 offset:8992
    ds_read_b128 a[244:247], v20 offset:9360
    v_smfmac_f32_16x16x64_bf16 v[96:99], v[172:175], a[248:255], v46
    ds_write_b16 v22, v220 offset:1284
    ds_write_b16_d16_hi v22, v220 offset:1604
    v_smfmac_f32_16x16x64_bf16 v[100:103], v[168:171], a[248:255], v46
    ds_write_b16 v22, v221 offset:1924
    ds_write_b16_d16_hi v22, v221 offset:2244
    v_smfmac_f32_16x16x64_bf16 v[104:107], v[164:167], a[248:255], v46
    ds_write_b16 v22, v222 offset:2560
    ds_write_b16_d16_hi v22, v222 offset:2880
    v_add_f32 v26, v26, v96
    v_fmac_f32 v27, v96, v96
    v_smfmac_f32_16x16x64_bf16 v[108:111], v[160:163], a[248:255], v46
    s_waitcnt lgkmcnt(15)
    s_waitcnt vmcnt(12)
    ds_write2_b64 v242, a[104:105], a[106:107] offset0:0 offset1:22
    buffer_load_dwordx4 a[148:151], v205, s[16:19], 0 offen offset:256
    v_subrev_u32 v242, s69, v242
    v_add_f32 v26, v26, v97
    v_fmac_f32 v27, v97, v97
    v_smfmac_f32_16x16x64_bf16 v[100:103], v[172:175], a[208:215], v46
    ds_read_b128 a[248:251], v20 offset:9728
    ds_read_b128 a[252:255], v20 offset:10096
    v_add_f32 v26, v26, v98
    v_fmac_f32 v27, v98, v98
    v_smfmac_f32_16x16x64_bf16 v[104:107], v[168:171], a[208:215], v46
    ds_write_b16 v22, v223 offset:3200
    ds_write_b16_d16_hi v22, v223 offset:3520
    v_add_f32 v26, v26, v99
    v_fmac_f32 v27, v99, v99
    v_smfmac_f32_16x16x64_bf16 v[108:111], v[164:167], a[208:215], v46
    ds_read_b128 a[208:211], v20 offset:10464
    ds_read_b128 a[212:215], v20 offset:10832
    v_add_f32 v28, v28, v100
    v_fmac_f32 v29, v100, v100
    v_smfmac_f32_16x16x64_bf16 v[104:107], v[172:175], a[216:223], v46
    ds_write_b16 v22, v222 offset:3844
    ds_write_b16_d16_hi v22, v222 offset:4164
    v_add_f32 v28, v28, v101
    v_fmac_f32 v29, v101, v101
    v_smfmac_f32_16x16x64_bf16 v[108:111], v[168:171], a[216:223], v46
    s_waitcnt vmcnt(12)
    ds_write2_b64 v243, a[108:109], a[110:111] offset0:0 offset1:22
    buffer_load_dwordx4 a[152:155], v206, s[16:19], 0 offen offset:256
    v_subrev_u32 v243, s69, v243
    v_add_f32 v28, v28, v102
    v_fmac_f32 v29, v102, v102
    v_mfma_f32_32x32x16_bf16 a[32:47], v[34:37], v[4:7], 0
    ds_read_b128 a[216:219], v20 offset:11200
    ds_read_b128 a[220:223], v20 offset:11568
    ds_read_b64 v[4:5], v24 offset:32688
    v_add_f32 v28, v28, v103
    v_fmac_f32 v29, v103, v103
    v_add_f32 v30, v30, v104
    v_smfmac_f32_16x16x64_bf16 v[108:111], v[172:175], a[224:231], v46
    ds_read_b128 a[224:227], v20 offset:11936
    ds_read_b128 a[228:231], v20 offset:12304
    v_fmac_f32 v31, v104, v104
    v_add_f32 v30, v30, v105
    v_mfma_f32_32x32x16_bf16 a[32:47], v[38:41], v[8:11], a[32:47]
    s_waitcnt lgkmcnt(15)
    ds_read_b64 v[6:7], v24 offset:32864
    ds_read_b64 v[8:9], v24 offset:48848
    ds_read_b64 v[10:11], v24 offset:49024
    v_fmac_f32 v31, v105, v105
    v_add_f32 v30, v30, v106
    v_fmac_f32 v31, v106, v106
    v_smfmac_f32_16x16x64_bf16 v[112:115], v[176:179], a[232:239], v46
    ds_read_b128 a[232:235], v20 offset:12672
    ds_read_b128 a[236:239], v20 offset:13040
    v_add_f32 v30, v30, v107
    v_fmac_f32 v31, v107, v107
    v_mfma_f32_32x32x16_bf16 v[128:143], v[42:45], v[42:45], 0
    s_waitcnt vmcnt(12)
    ds_write2_b64 v244, a[112:113], a[114:115] offset0:0 offset1:22
    buffer_load_dwordx4 a[156:159], v207, s[16:19], 0 offen offset:256
    v_subrev_u32 v244, s69, v244
    v_add_f32 v32, v32, v108
    v_fmac_f32 v33, v108, v108
    v_add_f32 v32, v32, v109
    v_smfmac_f32_16x16x64_bf16 v[112:115], v[180:183], a[240:247], v46
    ds_write_b16 v22, v223 offset:4484
    ds_write_b16_d16_hi v22, v223 offset:4804
    v_fmac_f32 v33, v109, v109
    v_add_f32 v32, v32, v110
    v_smfmac_f32_16x16x64_bf16 v[116:119], v[176:179], a[240:247], v46
    s_waitcnt lgkmcnt(15)
    v_fmac_f32 v33, v110, v110
    v_add_f32 v32, v32, v111
    v_smfmac_f32_16x16x64_bf16 v[112:115], v[184:187], a[248:255], v46
    v_fmac_f32 v33, v111, v111
    v_smfmac_f32_16x16x64_bf16 v[116:119], v[180:183], a[248:255], v46
    s_waitcnt vmcnt(12)
    ds_write2_b64 v245, a[116:117], a[118:119] offset0:0 offset1:22
    buffer_load_dwordx4 a[160:163], v208, s[16:19], 0 offen offset:256
    v_subrev_u32 v245, s69, v245
    v_smfmac_f32_16x16x64_bf16 v[120:123], v[176:179], a[248:255], v46
    v_smfmac_f32_16x16x64_bf16 v[112:115], v[188:191], a[208:215], v46
    v_smfmac_f32_16x16x64_bf16 v[116:119], v[184:187], a[208:215], v46
    v_smfmac_f32_16x16x64_bf16 v[120:123], v[180:183], a[208:215], v46
    v_smfmac_f32_16x16x64_bf16 v[124:127], v[176:179], a[208:215], v46
    s_waitcnt lgkmcnt(12)
    s_waitcnt vmcnt(12)
    ds_write2_b64 v246, a[120:121], a[122:123] offset0:0 offset1:22
    buffer_load_dwordx4 a[164:167], v209, s[16:19], 0 offen offset:256
    v_subrev_u32 v246, s69, v246
    v_add_f32 v26, v26, v112
    v_fmac_f32 v27, v112, v112
    v_smfmac_f32_16x16x64_bf16 v[116:119], v[188:191], a[216:223], v46
    v_add_f32 v26, v26, v113
    v_fmac_f32 v27, v113, v113
    v_smfmac_f32_16x16x64_bf16 v[120:123], v[184:187], a[216:223], v46
    v_add_f32 v26, v26, v114
    v_fmac_f32 v27, v114, v114
    v_smfmac_f32_16x16x64_bf16 v[124:127], v[180:183], a[216:223], v46
    s_waitcnt lgkmcnt(10)
    v_add_f32 v26, v26, v115
    v_fmac_f32 v27, v115, v115
    v_smfmac_f32_16x16x64_bf16 v[120:123], v[188:191], a[224:231], v46
    v_add_f32 v28, v28, v116
    v_fmac_f32 v29, v116, v116
    v_smfmac_f32_16x16x64_bf16 v[124:127], v[184:187], a[224:231], v46
    s_waitcnt lgkmcnt(9)
    s_waitcnt vmcnt(12)
    ds_write2_b64 v247, a[124:125], a[126:127] offset0:0 offset1:22
    buffer_load_dwordx4 a[168:171], v210, s[16:19], 0 offen offset:256
    v_subrev_u32 v247, s69, v247
    v_add_f32 v28, v28, v117
    v_fmac_f32 v29, v117, v117
    v_mfma_f32_32x32x16_bf16 a[48:63], v[34:37], v[4:7], 0
    s_waitcnt lgkmcnt(6)
    v_add_f32 v28, v28, v118
    v_fmac_f32 v29, v118, v118
    v_add_f32 v28, v28, v119
    v_smfmac_f32_16x16x64_bf16 v[124:127], v[188:191], a[232:239], v46
    v_fmac_f32 v29, v119, v119
    v_add_f32 v30, v30, v120
    v_mfma_f32_32x32x16_bf16 a[48:63], v[38:41], v[8:11], a[48:63]
    v_fmac_f32 v31, v120, v120
    v_add_f32 v30, v30, v121
    v_fmac_f32 v31, v121, v121
    v_add_u32 v20, s69, v20
    v_add_u32 v24, s69, v24
    s_waitcnt lgkmcnt(0)
    s_barrier
    ds_read_b128 a[240:243], v20 offset:0
    ds_read_b128 a[244:247], v20 offset:368
    ds_read_b128 a[248:251], v20 offset:736
    ds_read_b128 a[252:255], v20 offset:1104
    ds_read_b128 a[208:211], v20 offset:1472
    ds_read_b128 a[212:215], v20 offset:1840
    ds_read_b128 a[216:219], v20 offset:2208
    ds_read_b128 a[220:223], v20 offset:2576
    v_add_f32 v30, v30, v122
    v_fmac_f32 v31, v122, v122
    v_add_f32 v30, v30, v123
    v_fmac_f32 v31, v123, v123
    v_add_f32 v32, v32, v124
    v_fmac_f32 v33, v124, v124
    v_add_f32 v32, v32, v125
    v_fmac_f32 v33, v125, v125
    v_add_f32 v32, v32, v126
    v_fmac_f32 v33, v126, v126
    v_add_f32 v32, v32, v127
    v_fmac_f32 v33, v127, v127
    s_waitcnt lgkmcnt(6)
    v_smfmac_f32_16x16x64_bf16 v[128:131], a[192:195], a[240:247], v46
    ds_read_b64 a[64:65], v24 offset:0
    ds_read_b128 a[224:227], v20 offset:2944
    v_mfma_f32_32x32x16_bf16 v[144:159], v[42:45], v[42:45], 0
    s_waitcnt lgkmcnt(6)
    s_waitcnt vmcnt(11)
    ds_write2_b64 v232, a[128:129], a[130:131] offset0:0 offset1:22
    buffer_load_dwordx4 a[172:175], v211, s[16:19], 0 offen offset:256
    v_smfmac_f32_16x16x64_bf16 v[128:131], a[196:199], a[248:255], v46
    ds_read_b128 a[228:231], v20 offset:3312
    ds_read_b128 a[232:235], v20 offset:3680
    v_smfmac_f32_16x16x64_bf16 v[132:135], a[192:195], a[248:255], v46
    s_waitcnt lgkmcnt(7)
    ds_read_b128 a[236:239], v20 offset:4048
    ds_read_b128 a[240:243], v20 offset:4416
    v_smfmac_f32_16x16x64_bf16 v[128:131], a[200:203], a[208:215], v46
    ds_read_b64 a[66:67], v24 offset:176
    ds_read_b128 a[244:247], v20 offset:4784
    v_smfmac_f32_16x16x64_bf16 v[132:135], a[196:199], a[208:215], v46
    s_waitcnt vmcnt(11)
    ds_write2_b64 v233, a[132:133], a[134:135] offset0:0 offset1:22
    buffer_load_dwordx4 a[176:179], v212, s[16:19], 0 offen offset:256
    v_smfmac_f32_16x16x64_bf16 v[136:139], a[192:195], a[208:215], v46
    s_waitcnt lgkmcnt(10)
    ds_read_b128 a[248:251], v20 offset:176
    ds_read_b128 a[252:255], v20 offset:544
    v_smfmac_f32_16x16x64_bf16 v[128:131], a[204:207], a[216:223], v46
    ds_read_b128 a[208:211], v20 offset:912
    ds_read_b128 a[212:215], v20 offset:1280
    v_smfmac_f32_16x16x64_bf16 v[132:135], a[200:203], a[216:223], v46
    ds_read_b64 a[68:69], v24 offset:16160
    v_smfmac_f32_16x16x64_bf16 v[136:139], a[196:199], a[216:223], v46
    s_waitcnt vmcnt(10)
    ds_write2_b64 v234, a[136:137], a[138:139] offset0:0 offset1:22
    buffer_load_dwordx4 a[180:183], v213, s[16:19], 0 offen offset:256
    v_add_f32 v26, v26, v128
    v_fmac_f32 v27, v128, v128
    v_smfmac_f32_16x16x64_bf16 v[140:143], a[192:195], a[216:223], v46
    s_waitcnt lgkmcnt(12)
    ds_read_b128 a[192:195], v21 offset:5120
    ds_read_b128 a[216:219], v20 offset:1648
    v_add_f32 v26, v26, v129
    v_fmac_f32 v27, v129, v129
    v_smfmac_f32_16x16x64_bf16 v[132:135], a[204:207], a[224:231], v46
    ds_read_b128 a[220:223], v20 offset:2016
    v_add_f32 v26, v26, v130
    v_fmac_f32 v27, v130, v130
    v_smfmac_f32_16x16x64_bf16 v[136:139], a[200:203], a[224:231], v46
    ds_read_b64 a[70:71], v24 offset:16336
    v_add_f32 v26, v26, v131
    v_fmac_f32 v27, v131, v131
    v_smfmac_f32_16x16x64_bf16 v[140:143], a[196:199], a[224:231], v46
    s_waitcnt lgkmcnt(14)
    ds_read_b128 a[196:199], v21 offset:5184
    s_waitcnt vmcnt(10)
    ds_write2_b64 v235, a[140:141], a[142:143] offset0:0 offset1:22
    buffer_load_dwordx4 a[184:187], v214, s[16:19], 0 offen offset:256
    v_add_f32 v28, v28, v132
    v_fmac_f32 v29, v132, v132
    v_smfmac_f32_16x16x64_bf16 v[136:139], a[204:207], a[232:239], v46
    ds_read_b128 a[224:227], v20 offset:2384
    ds_read_b128 a[228:231], v20 offset:2752
    v_add_f32 v28, v28, v133
    v_fmac_f32 v29, v133, v133
    v_smfmac_f32_16x16x64_bf16 v[140:143], a[200:203], a[232:239], v46
    s_waitcnt lgkmcnt(15)
    ds_read_b128 a[200:203], v21 offset:5248
    ds_read_b128 a[232:235], v20 offset:3120
    v_add_f32 v28, v28, v134
    v_fmac_f32 v29, v134, v134
    v_smfmac_f32_16x16x64_bf16 v[140:143], a[204:207], a[240:247], v46
    s_waitcnt lgkmcnt(9)
    ds_read_b128 a[204:207], v21 offset:5312
    ds_read_b64 a[72:73], v24 offset:368
    v_add_f32 v28, v28, v135
    v_fmac_f32 v29, v135, v135
    v_smfmac_f32_16x16x64_bf16 v[144:147], a[192:195], a[248:255], v46
    ds_read_b128 a[236:239], v20 offset:3488
    ds_read_b128 a[240:243], v20 offset:3856
    v_add_f32 v30, v30, v136
    v_fmac_f32 v31, v136, v136
    v_mfma_f32_32x32x16_bf16 v[160:175], v[42:45], v[42:45], 0
    s_waitcnt lgkmcnt(9)
    s_waitcnt vmcnt(10)
    ds_write2_b64 v236, a[144:145], a[146:147] offset0:0 offset1:22
    buffer_load_dwordx4 a[188:191], v215, s[16:19], 0 offen offset:256
    v_add_f32 v30, v30, v137
    v_fmac_f32 v31, v137, v137
    v_add_f32 v30, v30, v138
    v_smfmac_f32_16x16x64_bf16 v[144:147], a[196:199], a[208:215], v46
    ds_read_b128 a[244:247], v20 offset:4224
    ds_read_b128 a[248:251], v20 offset:4592
    v_fmac_f32 v31, v138, v138
    v_add_f32 v30, v30, v139
    v_smfmac_f32_16x16x64_bf16 v[148:151], a[192:195], a[208:215], v46
    s_waitcnt lgkmcnt(8)
    ds_read_b64 a[74:75], v24 offset:544
    ds_read_b128 a[252:255], v20 offset:4960
    v_fmac_f32 v31, v139, v139
    v_add_f32 v32, v32, v140
    v_smfmac_f32_16x16x64_bf16 v[144:147], a[200:203], a[216:223], v46
    ds_read_b128 a[208:211], v20 offset:8080
    ds_read_b128 a[212:215], v20 offset:8448
    v_fmac_f32 v33, v140, v140
    v_add_f32 v32, v32, v141
    v_smfmac_f32_16x16x64_bf16 v[148:151], a[196:199], a[216:223], v46
    s_waitcnt vmcnt(10)
    ds_write2_b64 v237, a[148:149], a[150:151] offset0:0 offset1:22
    v_fmac_f32 v33, v141, v141
    v_add_f32 v32, v32, v142
    v_smfmac_f32_16x16x64_bf16 v[152:155], a[192:195], a[216:223], v46
    s_waitcnt lgkmcnt(11)
    ds_read_b128 a[216:219], v20 offset:8816
    ds_read_b128 a[220:223], v20 offset:9184
    v_fmac_f32 v33, v142, v142
    v_add_f32 v32, v32, v143
    v_smfmac_f32_16x16x64_bf16 v[144:147], a[204:207], a[224:231], v46
    ds_read_b64 a[76:77], v24 offset:16528
    ds_write_b16 v22, v248 offset:5120
    v_fmac_f32 v33, v143, v143
    v_smfmac_f32_16x16x64_bf16 v[148:151], a[200:203], a[224:231], v46
    ds_write_b16_d16_hi v22, v248 offset:5440
    ds_write_b16 v22, v249 offset:5760
    v_smfmac_f32_16x16x64_bf16 v[152:155], a[196:199], a[224:231], v46
    s_waitcnt vmcnt(9)
    ds_write2_b64 v238, a[152:153], a[154:155] offset0:0 offset1:22
    v_add_f32 v26, v26, v144
    v_fmac_f32 v27, v144, v144
    v_smfmac_f32_16x16x64_bf16 v[156:159], a[192:195], a[224:231], v46
    s_waitcnt lgkmcnt(15)
    ds_read_b128 a[192:195], v21 offset:0
    ds_read_b128 a[224:227], v20 offset:9552
    v_add_f32 v26, v26, v145
    v_fmac_f32 v27, v145, v145
    v_smfmac_f32_16x16x64_bf16 v[148:151], a[204:207], a[232:239], v46
    ds_read_b128 a[228:231], v20 offset:9920
    ds_read_b64 a[78:79], v24 offset:16704
    v_add_f32 v26, v26, v146
    v_fmac_f32 v27, v146, v146
    v_smfmac_f32_16x16x64_bf16 v[152:155], a[200:203], a[232:239], v46
    ds_write_b16_d16_hi v22, v249 offset:6080
    ds_write_b16 v22, v248 offset:6404
    v_add_f32 v26, v26, v147
    v_fmac_f32 v27, v147, v147
    v_smfmac_f32_16x16x64_bf16 v[156:159], a[196:199], a[232:239], v46
    s_waitcnt lgkmcnt(15)
    ds_read_b128 a[196:199], v21 offset:64
    s_waitcnt vmcnt(8)
    ds_write2_b64 v239, a[156:157], a[158:159] offset0:0 offset1:22
    v_add_f32 v28, v28, v148
    v_fmac_f32 v29, v148, v148
    v_smfmac_f32_16x16x64_bf16 v[152:155], a[204:207], a[240:247], v46
    ds_read_b128 a[232:235], v20 offset:10288
    ds_read_b128 a[236:239], v20 offset:10656
    v_add_f32 v28, v28, v149
    v_fmac_f32 v29, v149, v149
    v_smfmac_f32_16x16x64_bf16 v[156:159], a[200:203], a[240:247], v46
    ds_read_b128 a[200:203], v21 offset:128
    ds_read_b64 a[80:81], v24 offset:32320
    v_add_f32 v28, v28, v150
    v_fmac_f32 v29, v150, v150
    v_smfmac_f32_16x16x64_bf16 v[156:159], a[204:207], a[248:255], v46
    s_waitcnt lgkmcnt(11)
    ds_read_b128 a[204:207], v21 offset:192
    ds_read_b128 a[240:243], v20 offset:11024
    v_add_f32 v28, v28, v151
    v_fmac_f32 v29, v151, v151
    v_smfmac_f32_16x16x64_bf16 v[160:163], a[192:195], a[208:215], v46
    ds_read_b128 a[244:247], v20 offset:11392
    ds_read_b128 a[248:251], v20 offset:11760
    v_add_f32 v30, v30, v152
    v_fmac_f32 v31, v152, v152
    v_mfma_f32_32x32x16_bf16 v[176:191], v[42:45], v[42:45], 0
    s_waitcnt lgkmcnt(9)
    s_waitcnt vmcnt(7)
    ds_write2_b64 v240, a[160:161], a[162:163] offset0:0 offset1:22
    v_add_f32 v30, v30, v153
    v_fmac_f32 v31, v153, v153
    v_add_f32 v30, v30, v154
    v_smfmac_f32_16x16x64_bf16 v[160:163], a[196:199], a[216:223], v46
    ds_read_b64 a[82:83], v24 offset:32496
    ds_read_b128 a[252:255], v20 offset:12128
    v_fmac_f32 v31, v154, v154
    v_add_f32 v30, v30, v155
    v_smfmac_f32_16x16x64_bf16 v[164:167], a[192:195], a[216:223], v46
    s_waitcnt lgkmcnt(8)
    ds_read_b128 a[208:211], v20 offset:12496
    ds_read_b128 a[212:215], v20 offset:12864
    v_fmac_f32 v31, v155, v155
    v_add_f32 v32, v32, v156
    v_smfmac_f32_16x16x64_bf16 v[160:163], a[200:203], a[224:231], v46
    ds_read_b128 a[216:219], v20 offset:8256
    ds_read_b128 a[220:223], v20 offset:8624
    v_fmac_f32 v33, v156, v156
    v_add_f32 v32, v32, v157
    v_smfmac_f32_16x16x64_bf16 v[164:167], a[196:199], a[224:231], v46
    s_waitcnt vmcnt(6)
    ds_write2_b64 v241, a[164:165], a[166:167] offset0:0 offset1:22
    v_fmac_f32 v33, v157, v157
    v_add_f32 v32, v32, v158
    v_smfmac_f32_16x16x64_bf16 v[168:171], a[192:195], a[224:231], v46
    s_waitcnt lgkmcnt(11)
    ds_read_b64 a[84:85], v24 offset:48480
    ds_read_b128 a[224:227], v20 offset:8992
    v_fmac_f32 v33, v158, v158
    v_add_f32 v32, v32, v159
    v_smfmac_f32_16x16x64_bf16 v[160:163], a[204:207], a[232:239], v46
    ds_read_b128 a[228:231], v20 offset:9360
    ds_write_b16_d16_hi v22, v248 offset:6724
    v_fmac_f32 v33, v159, v159
    v_smfmac_f32_16x16x64_bf16 v[164:167], a[200:203], a[232:239], v46
    ds_write_b16 v22, v249 offset:7044
    ds_write_b16_d16_hi v22, v249 offset:7364
    v_smfmac_f32_16x16x64_bf16 v[168:171], a[196:199], a[232:239], v46
    s_waitcnt vmcnt(5)
    ds_write2_b64 v242, a[168:169], a[170:171] offset0:0 offset1:22
    v_add_f32 v26, v26, v160
    v_fmac_f32 v27, v160, v160
    v_smfmac_f32_16x16x64_bf16 v[172:175], a[192:195], a[232:239], v46
    s_waitcnt lgkmcnt(15)
    ds_read_b128 a[192:195], v21 offset:2560
    ds_read_b64 a[86:87], v24 offset:48656
    v_add_f32 v26, v26, v161
    v_fmac_f32 v27, v161, v161
    v_smfmac_f32_16x16x64_bf16 v[164:167], a[204:207], a[240:247], v46
    ds_read_b128 a[232:235], v20 offset:9728
    ds_read_b128 a[236:239], v20 offset:10096
    v_add_f32 v26, v26, v162
    v_fmac_f32 v27, v162, v162
    v_smfmac_f32_16x16x64_bf16 v[168:171], a[200:203], a[240:247], v46
    ds_write_b16 v22, v250 offset:0
    ds_write_b16_d16_hi v22, v250 offset:320
    v_add_f32 v26, v26, v163
    v_fmac_f32 v27, v163, v163
    v_smfmac_f32_16x16x64_bf16 v[172:175], a[196:199], a[240:247], v46
    s_waitcnt lgkmcnt(15)
    ds_read_b128 a[196:199], v21 offset:2624
    s_waitcnt vmcnt(4)
    ds_write2_b64 v243, a[172:173], a[174:175] offset0:0 offset1:22
    v_add_f32 v28, v28, v164
    v_fmac_f32 v29, v164, v164
    v_smfmac_f32_16x16x64_bf16 v[168:171], a[204:207], a[248:255], v46
    ds_read_b128 a[240:243], v20 offset:10464
    ds_read_b128 a[244:247], v20 offset:10832
    v_add_f32 v28, v28, v165
    v_fmac_f32 v29, v165, v165
    v_smfmac_f32_16x16x64_bf16 v[172:175], a[200:203], a[248:255], v46
    ds_read_b128 a[200:203], v21 offset:2688
    ds_read_b64 a[88:89], v24 offset:32688
    v_add_f32 v28, v28, v166
    v_fmac_f32 v29, v166, v166
    v_smfmac_f32_16x16x64_bf16 v[172:175], a[204:207], a[208:215], v46
    s_waitcnt lgkmcnt(11)
    ds_read_b128 a[204:207], v21 offset:2752
    ds_read_b128 a[248:251], v20 offset:11200
    v_add_f32 v28, v28, v167
    v_fmac_f32 v29, v167, v167
    v_smfmac_f32_16x16x64_bf16 v[176:179], a[192:195], a[216:223], v46
    ds_read_b128 a[252:255], v20 offset:11568
    ds_read_b128 a[208:211], v20 offset:11936
    v_add_f32 v30, v30, v168
    v_fmac_f32 v31, v168, v168
    v_mfma_f32_32x32x16_bf16 v[192:207], v[42:45], v[42:45], 0
    s_waitcnt lgkmcnt(9)
    s_waitcnt vmcnt(3)
    ds_write2_b64 v244, a[176:177], a[178:179] offset0:0 offset1:22
    v_add_f32 v30, v30, v169
    v_fmac_f32 v31, v169, v169
    v_add_f32 v30, v30, v170
    v_smfmac_f32_16x16x64_bf16 v[176:179], a[196:199], a[224:231], v46
    ds_read_b64 a[90:91], v24 offset:32864
    ds_read_b128 a[212:215], v20 offset:12304
    v_fmac_f32 v31, v170, v170
    v_add_f32 v30, v30, v171
    v_smfmac_f32_16x16x64_bf16 v[180:183], a[192:195], a[224:231], v46
    s_waitcnt lgkmcnt(8)
    ds_read_b128 a[216:219], v20 offset:12672
    ds_read_b128 a[220:223], v20 offset:13040
    v_fmac_f32 v31, v171, v171
    v_add_f32 v32, v32, v172
    v_smfmac_f32_16x16x64_bf16 v[176:179], a[200:203], a[232:239], v46
    ds_write_b16 v22, v251 offset:640
    ds_write_b16_d16_hi v22, v251 offset:960
    v_fmac_f32 v33, v172, v172
    v_add_f32 v32, v32, v173
    v_smfmac_f32_16x16x64_bf16 v[180:183], a[196:199], a[232:239], v46
    s_waitcnt vmcnt(2)
    ds_write2_b64 v245, a[180:181], a[182:183] offset0:0 offset1:22
    v_fmac_f32 v33, v173, v173
    v_add_f32 v32, v32, v174
    v_smfmac_f32_16x16x64_bf16 v[184:187], a[192:195], a[232:239], v46
    s_waitcnt lgkmcnt(11)
    ds_read_b64 a[92:93], v24 offset:48848
    ds_write_b16 v22, v250 offset:1284
    v_fmac_f32 v33, v174, v174
    v_add_f32 v32, v32, v175
    v_smfmac_f32_16x16x64_bf16 v[176:179], a[204:207], a[240:247], v46
    ds_write_b16_d16_hi v22, v250 offset:1604
    ds_write_b16 v22, v251 offset:1924
    v_fmac_f32 v33, v175, v175
    v_smfmac_f32_16x16x64_bf16 v[180:183], a[200:203], a[240:247], v46
    ds_write_b16_d16_hi v22, v251 offset:2244
    ds_write_b16 v22, v252 offset:2560
    v_smfmac_f32_16x16x64_bf16 v[184:187], a[196:199], a[240:247], v46
    s_waitcnt vmcnt(1)
    ds_write2_b64 v246, a[184:185], a[186:187] offset0:0 offset1:22
    v_add_f32 v26, v26, v176
    v_fmac_f32 v27, v176, v176
    v_smfmac_f32_16x16x64_bf16 v[188:191], a[192:195], a[240:247], v46
    s_waitcnt lgkmcnt(15)
    ds_read_b128 a[192:195], v21 offset:5120
    ds_read_b64 a[94:95], v24 offset:49024
    v_add_f32 v26, v26, v177
    v_fmac_f32 v27, v177, v177
    v_smfmac_f32_16x16x64_bf16 v[180:183], a[204:207], a[248:255], v46
    ds_write_b16_d16_hi v22, v252 offset:2880
    ds_write_b16 v22, v253 offset:3200
    v_add_f32 v26, v26, v178
    v_fmac_f32 v27, v178, v178
    v_smfmac_f32_16x16x64_bf16 v[184:187], a[200:203], a[248:255], v46
    ds_write_b16_d16_hi v22, v253 offset:3520
    ds_write_b16 v22, v252 offset:3844
    v_add_f32 v26, v26, v179
    v_fmac_f32 v27, v179, v179
    v_smfmac_f32_16x16x64_bf16 v[188:191], a[196:199], a[248:255], v46
    s_waitcnt lgkmcnt(15)
    ds_read_b128 a[196:199], v21 offset:5184
    s_waitcnt vmcnt(0)
    ds_write2_b64 v247, a[188:189], a[190:191] offset0:0 offset1:22
    v_add_f32 v28, v28, v180
    v_fmac_f32 v29, v180, v180
    v_smfmac_f32_16x16x64_bf16 v[184:187], a[204:207], a[208:215], v46
    ds_write_b16_d16_hi v22, v252 offset:4164
    ds_write_b16 v22, v253 offset:4484
    v_add_f32 v28, v28, v181
    v_fmac_f32 v29, v181, v181
    v_smfmac_f32_16x16x64_bf16 v[188:191], a[200:203], a[208:215], v46
    ds_read_b128 a[200:203], v21 offset:5248
    ds_write_b16_d16_hi v22, v253 offset:4804
    v_add_f32 v28, v28, v182
    v_fmac_f32 v29, v182, v182
    v_smfmac_f32_16x16x64_bf16 v[188:191], a[204:207], a[216:223], v46
    ds_read_b128 a[204:207], v21 offset:5312
    ds_write_b16 v22, v254 offset:5120
    v_add_f32 v28, v28, v183
    v_fmac_f32 v29, v183, v183
    v_subrev_u32 v20, s69, v20
    v_subrev_u32 v24, s69, v24
    s_waitcnt lgkmcnt(0)
    s_barrier
    ds_read_b128 a[224:227], v20 offset:0
    ds_read_b128 a[228:231], v20 offset:368
    ds_read_b128 a[232:235], v20 offset:736
    ds_read_b128 a[236:239], v20 offset:1104
    ds_read_b128 a[240:243], v20 offset:1472
    ds_read_b128 a[244:247], v20 offset:1840
    ds_read_b128 a[248:251], v20 offset:2208
    ds_read_b128 a[252:255], v20 offset:2576
    v_add_f32 v30, v30, v184
    v_fmac_f32 v31, v184, v184
    v_add_f32 v30, v30, v185
    v_fmac_f32 v31, v185, v185
    v_add_f32 v30, v30, v186
    v_fmac_f32 v31, v186, v186
    v_add_f32 v30, v30, v187
    v_fmac_f32 v31, v187, v187
    v_add_f32 v32, v32, v188
    v_fmac_f32 v33, v188, v188
    v_add_f32 v32, v32, v189
    v_fmac_f32 v33, v189, v189
    v_add_f32 v32, v32, v190
    v_fmac_f32 v33, v190, v190
    v_add_f32 v32, v32, v191
    v_fmac_f32 v33, v191, v191
    s_waitcnt lgkmcnt(6)
    v_smfmac_f32_16x16x64_bf16 v[192:195], a[192:195], a[224:231], v46
    ds_read_b64 a[128:129], v24 offset:0
    ds_read_b128 a[208:211], v20 offset:2944
    v_mfma_f32_32x32x16_bf16 v[208:223], v[42:45], v[42:45], 0
    s_waitcnt lgkmcnt(6)
    ds_read_b128 a[212:215], v20 offset:3312
    ds_read_b128 a[216:219], v20 offset:3680
    ds_read_b128 a[220:223], v20 offset:4048
    v_smfmac_f32_16x16x64_bf16 v[192:195], a[196:199], a[232:239], v46
    ds_read_b128 a[224:227], v20 offset:4416
    ds_read_b128 a[228:231], v20 offset:4784
    v_smfmac_f32_16x16x64_bf16 v[196:199], a[192:195], a[232:239], v46
    s_waitcnt lgkmcnt(9)
    ds_read_b64 a[130:131], v24 offset:176
    ds_read_b128 a[232:235], v20 offset:176
    v_smfmac_f32_16x16x64_bf16 v[192:195], a[200:203], a[240:247], v46
    ds_read_b128 a[236:239], v20 offset:544
    ds_write_b16_d16_hi v22, v254 offset:5440
    v_smfmac_f32_16x16x64_bf16 v[196:199], a[196:199], a[240:247], v46
    s_add_u32 m0, s63, 98304
    s_nop 0
    buffer_load_dwordx4 v56, s[24:27], s64 offen offset:0 lds
    v_smfmac_f32_16x16x64_bf16 v[200:203], a[192:195], a[240:247], v46
    s_waitcnt lgkmcnt(11)
    ds_read_b128 a[240:243], v20 offset:912
    ds_read_b128 a[244:247], v20 offset:1280
    v_smfmac_f32_16x16x64_bf16 v[192:195], a[204:207], a[248:255], v46
    ds_read_b64 a[132:133], v24 offset:16160
    ds_write_b16 v22, v255 offset:5760
    v_smfmac_f32_16x16x64_bf16 v[196:199], a[200:203], a[248:255], v46
    ds_write_b16_d16_hi v22, v255 offset:6080
    ds_write_b16 v22, v254 offset:6404
    v_smfmac_f32_16x16x64_bf16 v[200:203], a[196:199], a[248:255], v46
    ds_write_b16_d16_hi v22, v254 offset:6724
    ds_write_b16 v22, v255 offset:7044
    v_add_f32 v26, v26, v192
    v_fmac_f32 v27, v192, v192
    v_smfmac_f32_16x16x64_bf16 v[204:207], a[192:195], a[248:255], v46
    s_waitcnt lgkmcnt(15)
    ds_read_b128 a[192:195], v21 offset:0
    ds_read_b128 a[248:251], v20 offset:1648
    v_add_f32 v26, v26, v193
    v_fmac_f32 v27, v193, v193
    v_smfmac_f32_16x16x64_bf16 v[196:199], a[204:207], a[208:215], v46
    ds_read_b128 a[252:255], v20 offset:2016
    ds_read_b64 a[134:135], v24 offset:16336
    v_add_f32 v26, v26, v194
    v_fmac_f32 v27, v194, v194
    v_smfmac_f32_16x16x64_bf16 v[200:203], a[200:203], a[208:215], v46
    ds_write_b16_d16_hi v22, v255 offset:7364
    v_add_f32 v26, v26, v195
    v_fmac_f32 v27, v195, v195
    v_smfmac_f32_16x16x64_bf16 v[204:207], a[196:199], a[208:215], v46
    s_waitcnt lgkmcnt(15)
    ds_read_b128 a[196:199], v21 offset:64
    buffer_load_dwordx4 v57, s[24:27], s64 offen offset:1024 lds
    v_add_f32 v28, v28, v196
    v_fmac_f32 v29, v196, v196
    v_smfmac_f32_16x16x64_bf16 v[200:203], a[204:207], a[216:223], v46
    ds_read_b128 a[208:211], v20 offset:2384
    ds_read_b128 a[212:215], v20 offset:2752
    v_add_f32 v28, v28, v197
    v_fmac_f32 v29, v197, v197
    v_smfmac_f32_16x16x64_bf16 v[204:207], a[200:203], a[216:223], v46
    ds_read_b128 a[200:203], v21 offset:128
    ds_read_b64 a[136:137], v24 offset:368
    v_add_f32 v28, v28, v198
    v_fmac_f32 v29, v198, v198
    v_smfmac_f32_16x16x64_bf16 v[204:207], a[204:207], a[224:231], v46
    s_waitcnt lgkmcnt(9)
    ds_read_b128 a[204:207], v21 offset:192
    ds_read_b128 a[216:219], v20 offset:3120
    v_add_f32 v28, v28, v199
    v_fmac_f32 v29, v199, v199
    v_smfmac_f32_16x16x64_bf16 v[208:211], a[192:195], a[232:239], v46
    ds_read_b128 a[220:223], v20 offset:3488
    ds_read_b128 a[224:227], v20 offset:3856
    v_add_f32 v30, v30, v200
    v_fmac_f32 v31, v200, v200
    v_mfma_f32_32x32x16_bf16 v[224:239], v[42:45], v[42:45], 0
    s_waitcnt lgkmcnt(8)
    ds_read_b128 a[228:231], v20 offset:4224
    ds_read_b128 a[232:235], v20 offset:4592
    ds_read_b128 a[236:239], v20 offset:4960
    v_add_f32 v30, v30, v201
    v_fmac_f32 v31, v201, v201
    v_add_f32 v30, v30, v202
    v_smfmac_f32_16x16x64_bf16 v[208:211], a[196:199], a[240:247], v46
    ds_read_b64 a[138:139], v24 offset:544
    v_fmac_f32 v31, v202, v202
    v_add_f32 v30, v30, v203
    v_smfmac_f32_16x16x64_bf16 v[212:215], a[192:195], a[240:247], v46
    s_waitcnt lgkmcnt(9)
    ds_read_b128 a[240:243], v20 offset:8080
    ds_read_b128 a[244:247], v20 offset:8448
    v_fmac_f32 v31, v203, v203
    v_add_f32 v32, v32, v204
    v_smfmac_f32_16x16x64_bf16 v[208:211], a[200:203], a[248:255], v46
    buffer_load_dwordx4 v58, s[24:27], s64 offen offset:2048 lds
    v_fmac_f32 v33, v204, v204
    v_add_f32 v32, v32, v205
    v_smfmac_f32_16x16x64_bf16 v[212:215], a[196:199], a[248:255], v46
    v_fmac_f32 v33, v205, v205
    v_add_f32 v32, v32, v206
    v_smfmac_f32_16x16x64_bf16 v[216:219], a[192:195], a[248:255], v46
    s_waitcnt lgkmcnt(9)
    ds_read_b64 a[140:141], v24 offset:16528
    ds_read_b128 a[248:251], v20 offset:8816
    v_fmac_f32 v33, v206, v206
    v_add_f32 v32, v32, v207
    v_smfmac_f32_16x16x64_bf16 v[208:211], a[204:207], a[208:215], v46
    ds_read_b128 a[252:255], v20 offset:9184
    v_fmac_f32 v33, v207, v207
    v_smfmac_f32_16x16x64_bf16 v[212:215], a[200:203], a[208:215], v46
    v_smfmac_f32_16x16x64_bf16 v[216:219], a[196:199], a[208:215], v46
    v_smfmac_f32_16x16x64_bf16 v[220:223], a[192:195], a[208:215], v46
    s_waitcnt lgkmcnt(10)
    ds_read_b128 a[192:195], v21 offset:2560
    ds_read_b64 a[142:143], v24 offset:16704
    v_add_f32 v26, v26, v208
    v_fmac_f32 v27, v208, v208
    v_smfmac_f32_16x16x64_bf16 v[212:215], a[204:207], a[216:223], v46
    ds_read_b128 a[208:211], v20 offset:9552
    ds_read_b128 a[212:215], v20 offset:9920
    v_add_f32 v26, v26, v209
    v_fmac_f32 v27, v209, v209
    v_smfmac_f32_16x16x64_bf16 v[216:219], a[200:203], a[216:223], v46
    s_add_u32 m0, s63, 101376
    s_nop 0
    buffer_load_dwordx4 v56, s[24:27], s65 offen offset:0 lds
    v_add_f32 v26, v26, v210
    v_fmac_f32 v27, v210, v210
    v_smfmac_f32_16x16x64_bf16 v[220:223], a[196:199], a[216:223], v46
    s_waitcnt lgkmcnt(12)
    ds_read_b128 a[196:199], v21 offset:2624
    ds_read_b128 a[216:219], v20 offset:10288
    v_add_f32 v26, v26, v211
    v_fmac_f32 v27, v211, v211
    v_smfmac_f32_16x16x64_bf16 v[216:219], a[204:207], a[224:231], v46
    ds_read_b128 a[220:223], v20 offset:10656
    ds_read_b64 a[144:145], v24 offset:32320
    v_add_f32 v28, v28, v212
    v_fmac_f32 v29, v212, v212
    v_smfmac_f32_16x16x64_bf16 v[220:223], a[200:203], a[224:231], v46
    s_waitcnt lgkmcnt(14)
    ds_read_b128 a[200:203], v21 offset:2688
    ds_read_b128 a[224:227], v20 offset:11024
    v_add_f32 v28, v28, v213
    v_fmac_f32 v29, v213, v213
    v_smfmac_f32_16x16x64_bf16 v[220:223], a[204:207], a[232:239], v46
    s_waitcnt lgkmcnt(9)
    ds_read_b128 a[204:207], v21 offset:2752
    ds_read_b128 a[228:231], v20 offset:11392
    v_add_f32 v28, v28, v214
    v_fmac_f32 v29, v214, v214
    v_smfmac_f32_16x16x64_bf16 v[224:227], a[192:195], a[240:247], v46
    ds_read_b128 a[232:235], v20 offset:11760
    ds_read_b128 a[236:239], v20 offset:12128
    v_add_f32 v28, v28, v215
    v_fmac_f32 v29, v215, v215
    v_mfma_f32_32x32x16_bf16 v[240:255], v[42:45], v[42:45], 0
    s_waitcnt lgkmcnt(9)
    ds_read_b64 a[146:147], v24 offset:32496
    ds_read_b128 a[240:243], v20 offset:12496
    ds_read_b128 a[244:247], v20 offset:12864
    v_add_f32 v30, v30, v216
    v_fmac_f32 v31, v216, v216
    v_add_f32 v30, v30, v217
    v_smfmac_f32_16x16x64_bf16 v[224:227], a[196:199], a[248:255], v46
    v_fmac_f32 v31, v217, v217
    v_add_f32 v30, v30, v218
    v_smfmac_f32_16x16x64_bf16 v[228:231], a[192:195], a[248:255], v46
    s_waitcnt lgkmcnt(8)
    buffer_load_dwordx4 v57, s[24:27], s65 offen offset:1024 lds
    v_fmac_f32 v31, v218, v218
    v_add_f32 v30, v30, v219
    v_smfmac_f32_16x16x64_bf16 v[224:227], a[200:203], a[208:215], v46
    ds_read_b128 a[248:251], v20 offset:8256
    ds_read_b128 a[252:255], v20 offset:8624
    v_fmac_f32 v31, v219, v219
    v_add_f32 v32, v32, v220
    v_smfmac_f32_16x16x64_bf16 v[228:231], a[196:199], a[208:215], v46
    ds_read_b64 a[148:149], v24 offset:48480
    v_fmac_f32 v33, v220, v220
    v_add_f32 v32, v32, v221
    v_smfmac_f32_16x16x64_bf16 v[232:235], a[192:195], a[208:215], v46
    s_waitcnt lgkmcnt(9)
    ds_read_b128 a[208:211], v20 offset:8992
    ds_read_b128 a[212:215], v20 offset:9360
    v_fmac_f32 v33, v221, v221
    v_add_f32 v32, v32, v222
    v_smfmac_f32_16x16x64_bf16 v[224:227], a[204:207], a[216:223], v46
    v_fmac_f32 v33, v222, v222
    v_add_f32 v32, v32, v223
    v_smfmac_f32_16x16x64_bf16 v[228:231], a[200:203], a[216:223], v46
    v_fmac_f32 v33, v223, v223
    v_smfmac_f32_16x16x64_bf16 v[232:235], a[196:199], a[216:223], v46
    ds_read_b64 a[150:151], v24 offset:48656
    v_smfmac_f32_16x16x64_bf16 v[236:239], a[192:195], a[216:223], v46
    s_waitcnt lgkmcnt(11)
    ds_read_b128 a[192:195], v21 offset:5120
    ds_read_b128 a[216:219], v20 offset:9728
    v_add_f32 v26, v26, v224
    v_fmac_f32 v27, v224, v224
    v_smfmac_f32_16x16x64_bf16 v[228:231], a[204:207], a[224:231], v46
    ds_read_b128 a[220:223], v20 offset:10096
    buffer_load_dwordx4 v58, s[24:27], s65 offen offset:2048 lds
    v_add_f32 v26, v26, v225
    v_fmac_f32 v27, v225, v225
    v_smfmac_f32_16x16x64_bf16 v[232:235], a[200:203], a[224:231], v46
    v_add_f32 v26, v26, v226
    v_fmac_f32 v27, v226, v226
    v_smfmac_f32_16x16x64_bf16 v[236:239], a[196:199], a[224:231], v46
    s_waitcnt lgkmcnt(12)
    ds_read_b128 a[196:199], v21 offset:5184
    ds_read_b128 a[224:227], v20 offset:10464
    v_add_f32 v26, v26, v227
    v_fmac_f32 v27, v227, v227
    v_smfmac_f32_16x16x64_bf16 v[232:235], a[204:207], a[232:239], v46
    ds_read_b128 a[228:231], v20 offset:10832
    ds_read_b64 a[152:153], v24 offset:32688
    v_add_f32 v28, v28, v228
    v_fmac_f32 v29, v228, v228
    v_smfmac_f32_16x16x64_bf16 v[236:239], a[200:203], a[232:239], v46
    s_waitcnt lgkmcnt(13)
    ds_read_b128 a[200:203], v21 offset:5248
    ds_read_b128 a[232:235], v20 offset:11200
    v_add_f32 v28, v28, v229
    v_fmac_f32 v29, v229, v229
    v_smfmac_f32_16x16x64_bf16 v[236:239], a[204:207], a[240:247], v46
    s_waitcnt lgkmcnt(8)
    ds_read_b128 a[204:207], v21 offset:5312
    ds_read_b128 a[236:239], v20 offset:11568
    v_add_f32 v28, v28, v230
    v_fmac_f32 v29, v230, v230
    v_smfmac_f32_16x16x64_bf16 v[240:243], a[192:195], a[248:255], v46
    s_waitcnt lgkmcnt(7)
    ds_read_b64 a[154:155], v24 offset:32864
    ds_read_b128 a[240:243], v20 offset:11936
    v_add_f32 v28, v28, v231
    v_fmac_f32 v29, v231, v231
    v_smfmac_f32_16x16x64_bf16 v[240:243], a[196:199], a[208:215], v46
    ds_read_b128 a[244:247], v20 offset:12304
    ds_read_b128 a[248:251], v20 offset:12672
    v_add_f32 v30, v30, v232
    v_fmac_f32 v31, v232, v232
    v_smfmac_f32_16x16x64_bf16 v[244:247], a[192:195], a[208:215], v46
    s_waitcnt lgkmcnt(7)
    buffer_load_dword v61, off, s[88:91], 0 sc1
    v_add_f32 v30, v30, v233
    v_fmac_f32 v31, v233, v233
    v_smfmac_f32_16x16x64_bf16 v[240:243], a[200:203], a[216:223], v46
    ds_read_b128 a[252:255], v20 offset:13040
    v_add_f32 v30, v30, v234
    v_fmac_f32 v31, v234, v234
    v_smfmac_f32_16x16x64_bf16 v[244:247], a[196:199], a[216:223], v46
    ds_read_b64 a[156:157], v24 offset:48848
    v_add_f32 v30, v30, v235
    v_fmac_f32 v31, v235, v235
    v_smfmac_f32_16x16x64_bf16 v[248:251], a[192:195], a[216:223], v46
    s_waitcnt lgkmcnt(7)
    v_add_f32 v32, v32, v236
    v_fmac_f32 v33, v236, v236
    v_smfmac_f32_16x16x64_bf16 v[240:243], a[204:207], a[224:231], v46
    v_add_f32 v32, v32, v237
    v_fmac_f32 v33, v237, v237
    v_smfmac_f32_16x16x64_bf16 v[244:247], a[200:203], a[224:231], v46
    v_add_f32 v32, v32, v238
    v_fmac_f32 v33, v238, v238
    v_smfmac_f32_16x16x64_bf16 v[248:251], a[196:199], a[224:231], v46
    ds_read_b64 a[158:159], v24 offset:49024
    v_add_f32 v32, v32, v239
    v_fmac_f32 v33, v239, v239
    v_smfmac_f32_16x16x64_bf16 v[252:255], a[192:195], a[224:231], v46
    s_waitcnt lgkmcnt(7)
    v_add_f32 v26, v26, v240
    v_fmac_f32 v27, v240, v240
    v_smfmac_f32_16x16x64_bf16 v[244:247], a[204:207], a[232:239], v46
    v_add_f32 v26, v26, v241
    v_fmac_f32 v27, v241, v241
    v_smfmac_f32_16x16x64_bf16 v[248:251], a[200:203], a[232:239], v46
    v_add_f32 v26, v26, v242
    v_fmac_f32 v27, v242, v242
    v_smfmac_f32_16x16x64_bf16 v[252:255], a[196:199], a[232:239], v46
    s_waitcnt lgkmcnt(4)
    v_add_f32 v26, v26, v243
    v_fmac_f32 v27, v243, v243
    v_smfmac_f32_16x16x64_bf16 v[248:251], a[204:207], a[240:247], v46
    v_add_f32 v28, v28, v244
    v_fmac_f32 v29, v244, v244
    v_smfmac_f32_16x16x64_bf16 v[252:255], a[200:203], a[240:247], v46
    s_waitcnt lgkmcnt(2)
    v_add_f32 v28, v28, v245
    v_fmac_f32 v29, v245, v245
    v_smfmac_f32_16x16x64_bf16 v[252:255], a[204:207], a[248:255], v46
    v_add_f32 v28, v28, v246
    v_fmac_f32 v29, v246, v246
    v_and_b32 v3, 63, v0
    v_lshlrev_b32 v1, 4, v3
    v_add_u32 v12, 147456, v1
    v_lshlrev_b32 v2, 4, v0
    v_add_u32 v2, 147456, v2
    s_mov_b32 s53, 0x3baaaaab
    s_mov_b32 s54, 0x3727c5ac
    s_nop 0
    v_add_f32 v28, v28, v247
    v_fmac_f32 v29, v247, v247
    v_add_f32 v30, v30, v248
    v_fmac_f32 v31, v248, v248
    v_add_f32 v30, v30, v249
    v_fmac_f32 v31, v249, v249
    v_add_f32 v30, v30, v250
    v_fmac_f32 v31, v250, v250
    v_add_f32 v30, v30, v251
    v_fmac_f32 v31, v251, v251
    v_add_f32 v32, v32, v252
    v_fmac_f32 v33, v252, v252
    v_add_f32 v32, v32, v253
    v_fmac_f32 v33, v253, v253
    v_add_f32 v32, v32, v254
    v_fmac_f32 v33, v254, v254
    v_add_f32 v32, v32, v255
    v_fmac_f32 v33, v255, v255
    ds_write_b128 v2, v[26:29]
    ds_write_b128 v2, v[30:33] offset:4096
    v_lshrrev_b32 v2, 5, v3
    v_mul_u32_u24 v2, 12288, v2
    v_and_b32 v19, 31, v3
    v_lshl_add_u32 v2, v19, 4, v2
    s_lshl_b32 s52, s40, 10
    v_add_u32 v2, s52, v2
    v_add_u32 v19, 49152, v2
    s_mul_i32 s52, s40, 24576
    v_add_u32 v1, s52, v1
    s_add_u32 s64, s63, 1073152
    s_add_u32 s65, s63, 1076224
    s_add_u32 s66, s63, 1343488
    s_add_u32 s67, s63, 1346560
    s_add_u32 s63, s63, 24576
    s_mov_b32 s56, 0x10000
    s_waitcnt vmcnt(0)
L_poll:
    v_readfirstlane_b32 s55, v61
    s_sub_u32 s56, s56, 1
    s_cmp_ge_u32 s55, 24
    s_cbranch_scc1 L_ready
    buffer_load_dword v61, off, s[88:91], 0 sc1
    s_cmp_lg_u32 s56, 0
    s_waitcnt vmcnt(0)
    s_cbranch_scc1 L_poll
    s_branch L_ready
.p2align 6
.fill 2, 4, 0xbf800000
L_ready:
    s_waitcnt lgkmcnt(0)
    s_barrier
    ds_read_b128 v[4:7], v12 offset:0
    ds_read_b128 v[8:11], v12 offset:1024
    ds_read_b128 v[14:17], v12 offset:2048
    ds_read_b128 v[46:49], v12 offset:3072
    ds_read_b128 v[42:45], v12 offset:4096
    ds_read_b128 v[20:23], v12 offset:5120
    ds_read_b128 v[30:33], v12 offset:6144
    ds_read_b128 v[26:29], v12 offset:7168
    s_waitcnt lgkmcnt(6)
    v_pk_add_f32 v[4:5], v[4:5], v[8:9]
    s_waitcnt lgkmcnt(4)
    v_pk_add_f32 v[14:15], v[14:15], v[46:47]
    v_pk_add_f32 v[6:7], v[6:7], v[10:11]
    v_pk_add_f32 v[16:17], v[16:17], v[48:49]
    v_pk_add_f32 v[4:5], v[4:5], v[14:15]
    v_pk_add_f32 v[6:7], v[6:7], v[16:17]
    s_waitcnt lgkmcnt(2)
    v_pk_add_f32 v[42:43], v[42:43], v[20:21]
    s_waitcnt lgkmcnt(0)
    v_pk_add_f32 v[30:31], v[30:31], v[26:27]
    v_pk_add_f32 v[44:45], v[44:45], v[22:23]
    v_pk_add_f32 v[32:33], v[32:33], v[28:29]
    v_pk_add_f32 v[42:43], v[42:43], v[30:31]
    v_pk_add_f32 v[44:45], v[44:45], v[32:33]
    v_mul_f32 v4, s53, v4
    v_mul_f32 v6, s53, v6
    v_mul_f32 v42, s53, v42
    v_mul_f32 v44, s53, v44
    v_mul_f32 v8, v4, v4
    v_mul_f32 v9, v6, v6
    v_mul_f32 v10, v42, v42
    v_mul_f32 v11, v44, v44
    v_fma_f32 v8, v5, s53, -v8
    v_fma_f32 v9, v7, s53, -v9
    v_fma_f32 v10, v43, s53, -v10
    v_fma_f32 v11, v45, s53, -v11
    v_max_f32 v8, 0, v8
    v_max_f32 v9, 0, v9
    v_max_f32 v10, 0, v10
    v_max_f32 v11, 0, v11
    v_add_f32 v8, s54, v8
    v_add_f32 v9, s54, v9
    v_add_f32 v10, s54, v10
    v_add_f32 v11, s54, v11
    v_rsq_f32 v8, v8
    v_rsq_f32 v9, v9
    v_rsq_f32 v10, v10
    v_rsq_f32 v11, v11
    v_mul_f32 v26, s61, v8
    v_mul_f32 v28, s61, v9
    v_mul_f32 v30, s61, v10
    v_mul_f32 v32, s61, v11
    v_mul_f32 v27, v4, v26
    v_mul_f32 v29, v6, v28
    v_mul_f32 v31, v42, v30
    v_mul_f32 v33, v44, v32
L_norm:
    v_pk_fma_f32 v[64:65], v[64:65], v[26:27], v[26:27] op_sel:[0,0,1] op_sel_hi:[1,0,1] neg_lo:[0,0,1] neg_hi:[0,0,1]
    v_pk_fma_f32 v[66:67], v[66:67], v[26:27], v[26:27] op_sel:[0,0,1] op_sel_hi:[1,0,1] neg_lo:[0,0,1] neg_hi:[0,0,1]
    v_pk_fma_f32 v[80:81], v[80:81], v[26:27], v[26:27] op_sel:[0,0,1] op_sel_hi:[1,0,1] neg_lo:[0,0,1] neg_hi:[0,0,1]
    v_pk_fma_f32 v[82:83], v[82:83], v[26:27], v[26:27] op_sel:[0,0,1] op_sel_hi:[1,0,1] neg_lo:[0,0,1] neg_hi:[0,0,1]
    v_cvt_pk_bf16_f32 v4, v64, v65
    v_cvt_pk_bf16_f32 v5, v66, v67
    v_cvt_pk_bf16_f32 v6, v80, v81
    v_cvt_pk_bf16_f32 v7, v82, v83
    ds_write_b128 v2, v[4:7] offset:0
    v_pk_fma_f32 v[68:69], v[68:69], v[28:29], v[28:29] op_sel:[0,0,1] op_sel_hi:[1,0,1] neg_lo:[0,0,1] neg_hi:[0,0,1]
    v_pk_fma_f32 v[70:71], v[70:71], v[28:29], v[28:29] op_sel:[0,0,1] op_sel_hi:[1,0,1] neg_lo:[0,0,1] neg_hi:[0,0,1]
    v_pk_fma_f32 v[84:85], v[84:85], v[28:29], v[28:29] op_sel:[0,0,1] op_sel_hi:[1,0,1] neg_lo:[0,0,1] neg_hi:[0,0,1]
    v_pk_fma_f32 v[86:87], v[86:87], v[28:29], v[28:29] op_sel:[0,0,1] op_sel_hi:[1,0,1] neg_lo:[0,0,1] neg_hi:[0,0,1]
    v_cvt_pk_bf16_f32 v8, v68, v69
    v_cvt_pk_bf16_f32 v9, v70, v71
    v_cvt_pk_bf16_f32 v10, v84, v85
    v_cvt_pk_bf16_f32 v11, v86, v87
    ds_write_b128 v2, v[8:11] offset:24576
    v_pk_fma_f32 v[72:73], v[72:73], v[30:31], v[30:31] op_sel:[0,0,1] op_sel_hi:[1,0,1] neg_lo:[0,0,1] neg_hi:[0,0,1]
    v_pk_fma_f32 v[74:75], v[74:75], v[30:31], v[30:31] op_sel:[0,0,1] op_sel_hi:[1,0,1] neg_lo:[0,0,1] neg_hi:[0,0,1]
    v_pk_fma_f32 v[88:89], v[88:89], v[30:31], v[30:31] op_sel:[0,0,1] op_sel_hi:[1,0,1] neg_lo:[0,0,1] neg_hi:[0,0,1]
    v_pk_fma_f32 v[90:91], v[90:91], v[30:31], v[30:31] op_sel:[0,0,1] op_sel_hi:[1,0,1] neg_lo:[0,0,1] neg_hi:[0,0,1]
    v_cvt_pk_bf16_f32 v14, v72, v73
    v_cvt_pk_bf16_f32 v15, v74, v75
    v_cvt_pk_bf16_f32 v16, v88, v89
    v_cvt_pk_bf16_f32 v17, v90, v91
    ds_write_b128 v19, v[14:17] offset:0
    v_pk_fma_f32 v[76:77], v[76:77], v[32:33], v[32:33] op_sel:[0,0,1] op_sel_hi:[1,0,1] neg_lo:[0,0,1] neg_hi:[0,0,1]
    v_pk_fma_f32 v[78:79], v[78:79], v[32:33], v[32:33] op_sel:[0,0,1] op_sel_hi:[1,0,1] neg_lo:[0,0,1] neg_hi:[0,0,1]
    v_pk_fma_f32 v[92:93], v[92:93], v[32:33], v[32:33] op_sel:[0,0,1] op_sel_hi:[1,0,1] neg_lo:[0,0,1] neg_hi:[0,0,1]
    v_pk_fma_f32 v[94:95], v[94:95], v[32:33], v[32:33] op_sel:[0,0,1] op_sel_hi:[1,0,1] neg_lo:[0,0,1] neg_hi:[0,0,1]
    v_cvt_pk_bf16_f32 v42, v76, v77
    v_cvt_pk_bf16_f32 v43, v78, v79
    v_cvt_pk_bf16_f32 v44, v92, v93
    v_cvt_pk_bf16_f32 v45, v94, v95
    ds_write_b128 v19, v[42:45] offset:24576
    v_pk_fma_f32 v[96:97], v[96:97], v[26:27], v[26:27] op_sel:[0,0,1] op_sel_hi:[1,0,1] neg_lo:[0,0,1] neg_hi:[0,0,1]
    v_pk_fma_f32 v[98:99], v[98:99], v[26:27], v[26:27] op_sel:[0,0,1] op_sel_hi:[1,0,1] neg_lo:[0,0,1] neg_hi:[0,0,1]
    v_pk_fma_f32 v[112:113], v[112:113], v[26:27], v[26:27] op_sel:[0,0,1] op_sel_hi:[1,0,1] neg_lo:[0,0,1] neg_hi:[0,0,1]
    v_pk_fma_f32 v[114:115], v[114:115], v[26:27], v[26:27] op_sel:[0,0,1] op_sel_hi:[1,0,1] neg_lo:[0,0,1] neg_hi:[0,0,1]
    v_cvt_pk_bf16_f32 v46, v96, v97
    v_cvt_pk_bf16_f32 v47, v98, v99
    v_cvt_pk_bf16_f32 v48, v112, v113
    v_cvt_pk_bf16_f32 v49, v114, v115
    ds_write_b128 v2, v[46:49] offset:512
    v_pk_fma_f32 v[100:101], v[100:101], v[28:29], v[28:29] op_sel:[0,0,1] op_sel_hi:[1,0,1] neg_lo:[0,0,1] neg_hi:[0,0,1]
    v_pk_fma_f32 v[102:103], v[102:103], v[28:29], v[28:29] op_sel:[0,0,1] op_sel_hi:[1,0,1] neg_lo:[0,0,1] neg_hi:[0,0,1]
    v_pk_fma_f32 v[116:117], v[116:117], v[28:29], v[28:29] op_sel:[0,0,1] op_sel_hi:[1,0,1] neg_lo:[0,0,1] neg_hi:[0,0,1]
    v_pk_fma_f32 v[118:119], v[118:119], v[28:29], v[28:29] op_sel:[0,0,1] op_sel_hi:[1,0,1] neg_lo:[0,0,1] neg_hi:[0,0,1]
    v_cvt_pk_bf16_f32 v4, v100, v101
    v_cvt_pk_bf16_f32 v5, v102, v103
    v_cvt_pk_bf16_f32 v6, v116, v117
    v_cvt_pk_bf16_f32 v7, v118, v119
    ds_write_b128 v2, v[4:7] offset:25088
    v_pk_fma_f32 v[104:105], v[104:105], v[30:31], v[30:31] op_sel:[0,0,1] op_sel_hi:[1,0,1] neg_lo:[0,0,1] neg_hi:[0,0,1]
    v_pk_fma_f32 v[106:107], v[106:107], v[30:31], v[30:31] op_sel:[0,0,1] op_sel_hi:[1,0,1] neg_lo:[0,0,1] neg_hi:[0,0,1]
    v_pk_fma_f32 v[120:121], v[120:121], v[30:31], v[30:31] op_sel:[0,0,1] op_sel_hi:[1,0,1] neg_lo:[0,0,1] neg_hi:[0,0,1]
    v_pk_fma_f32 v[122:123], v[122:123], v[30:31], v[30:31] op_sel:[0,0,1] op_sel_hi:[1,0,1] neg_lo:[0,0,1] neg_hi:[0,0,1]
    v_cvt_pk_bf16_f32 v8, v104, v105
    v_cvt_pk_bf16_f32 v9, v106, v107
    v_cvt_pk_bf16_f32 v10, v120, v121
    v_cvt_pk_bf16_f32 v11, v122, v123
    ds_write_b128 v19, v[8:11] offset:512
    v_pk_fma_f32 v[108:109], v[108:109], v[32:33], v[32:33] op_sel:[0,0,1] op_sel_hi:[1,0,1] neg_lo:[0,0,1] neg_hi:[0,0,1]
    v_pk_fma_f32 v[110:111], v[110:111], v[32:33], v[32:33] op_sel:[0,0,1] op_sel_hi:[1,0,1] neg_lo:[0,0,1] neg_hi:[0,0,1]
    v_pk_fma_f32 v[124:125], v[124:125], v[32:33], v[32:33] op_sel:[0,0,1] op_sel_hi:[1,0,1] neg_lo:[0,0,1] neg_hi:[0,0,1]
    v_pk_fma_f32 v[126:127], v[126:127], v[32:33], v[32:33] op_sel:[0,0,1] op_sel_hi:[1,0,1] neg_lo:[0,0,1] neg_hi:[0,0,1]
    v_cvt_pk_bf16_f32 v14, v108, v109
    v_cvt_pk_bf16_f32 v15, v110, v111
    v_cvt_pk_bf16_f32 v16, v124, v125
    v_cvt_pk_bf16_f32 v17, v126, v127
    ds_write_b128 v19, v[14:17] offset:25088
    v_pk_fma_f32 v[128:129], v[128:129], v[26:27], v[26:27] op_sel:[0,0,1] op_sel_hi:[1,0,1] neg_lo:[0,0,1] neg_hi:[0,0,1]
    v_pk_fma_f32 v[130:131], v[130:131], v[26:27], v[26:27] op_sel:[0,0,1] op_sel_hi:[1,0,1] neg_lo:[0,0,1] neg_hi:[0,0,1]
    v_pk_fma_f32 v[144:145], v[144:145], v[26:27], v[26:27] op_sel:[0,0,1] op_sel_hi:[1,0,1] neg_lo:[0,0,1] neg_hi:[0,0,1]
    v_pk_fma_f32 v[146:147], v[146:147], v[26:27], v[26:27] op_sel:[0,0,1] op_sel_hi:[1,0,1] neg_lo:[0,0,1] neg_hi:[0,0,1]
    v_cvt_pk_bf16_f32 v42, v128, v129
    v_cvt_pk_bf16_f32 v43, v130, v131
    v_cvt_pk_bf16_f32 v44, v144, v145
    v_cvt_pk_bf16_f32 v45, v146, v147
    ds_write_b128 v2, v[42:45] offset:4096
    v_pk_fma_f32 v[132:133], v[132:133], v[28:29], v[28:29] op_sel:[0,0,1] op_sel_hi:[1,0,1] neg_lo:[0,0,1] neg_hi:[0,0,1]
    v_pk_fma_f32 v[134:135], v[134:135], v[28:29], v[28:29] op_sel:[0,0,1] op_sel_hi:[1,0,1] neg_lo:[0,0,1] neg_hi:[0,0,1]
    v_pk_fma_f32 v[148:149], v[148:149], v[28:29], v[28:29] op_sel:[0,0,1] op_sel_hi:[1,0,1] neg_lo:[0,0,1] neg_hi:[0,0,1]
    v_pk_fma_f32 v[150:151], v[150:151], v[28:29], v[28:29] op_sel:[0,0,1] op_sel_hi:[1,0,1] neg_lo:[0,0,1] neg_hi:[0,0,1]
    v_cvt_pk_bf16_f32 v46, v132, v133
    v_cvt_pk_bf16_f32 v47, v134, v135
    v_cvt_pk_bf16_f32 v48, v148, v149
    v_cvt_pk_bf16_f32 v49, v150, v151
    ds_write_b128 v2, v[46:49] offset:28672
    v_pk_fma_f32 v[136:137], v[136:137], v[30:31], v[30:31] op_sel:[0,0,1] op_sel_hi:[1,0,1] neg_lo:[0,0,1] neg_hi:[0,0,1]
    v_pk_fma_f32 v[138:139], v[138:139], v[30:31], v[30:31] op_sel:[0,0,1] op_sel_hi:[1,0,1] neg_lo:[0,0,1] neg_hi:[0,0,1]
    v_pk_fma_f32 v[152:153], v[152:153], v[30:31], v[30:31] op_sel:[0,0,1] op_sel_hi:[1,0,1] neg_lo:[0,0,1] neg_hi:[0,0,1]
    v_pk_fma_f32 v[154:155], v[154:155], v[30:31], v[30:31] op_sel:[0,0,1] op_sel_hi:[1,0,1] neg_lo:[0,0,1] neg_hi:[0,0,1]
    v_cvt_pk_bf16_f32 v4, v136, v137
    v_cvt_pk_bf16_f32 v5, v138, v139
    v_cvt_pk_bf16_f32 v6, v152, v153
    v_cvt_pk_bf16_f32 v7, v154, v155
    ds_write_b128 v19, v[4:7] offset:4096
    v_pk_fma_f32 v[140:141], v[140:141], v[32:33], v[32:33] op_sel:[0,0,1] op_sel_hi:[1,0,1] neg_lo:[0,0,1] neg_hi:[0,0,1]
    v_pk_fma_f32 v[142:143], v[142:143], v[32:33], v[32:33] op_sel:[0,0,1] op_sel_hi:[1,0,1] neg_lo:[0,0,1] neg_hi:[0,0,1]
    v_pk_fma_f32 v[156:157], v[156:157], v[32:33], v[32:33] op_sel:[0,0,1] op_sel_hi:[1,0,1] neg_lo:[0,0,1] neg_hi:[0,0,1]
    v_pk_fma_f32 v[158:159], v[158:159], v[32:33], v[32:33] op_sel:[0,0,1] op_sel_hi:[1,0,1] neg_lo:[0,0,1] neg_hi:[0,0,1]
    v_cvt_pk_bf16_f32 v8, v140, v141
    v_cvt_pk_bf16_f32 v9, v142, v143
    v_cvt_pk_bf16_f32 v10, v156, v157
    v_cvt_pk_bf16_f32 v11, v158, v159
    ds_write_b128 v19, v[8:11] offset:28672
    v_pk_fma_f32 v[160:161], v[160:161], v[26:27], v[26:27] op_sel:[0,0,1] op_sel_hi:[1,0,1] neg_lo:[0,0,1] neg_hi:[0,0,1]
    v_pk_fma_f32 v[162:163], v[162:163], v[26:27], v[26:27] op_sel:[0,0,1] op_sel_hi:[1,0,1] neg_lo:[0,0,1] neg_hi:[0,0,1]
    v_pk_fma_f32 v[176:177], v[176:177], v[26:27], v[26:27] op_sel:[0,0,1] op_sel_hi:[1,0,1] neg_lo:[0,0,1] neg_hi:[0,0,1]
    v_pk_fma_f32 v[178:179], v[178:179], v[26:27], v[26:27] op_sel:[0,0,1] op_sel_hi:[1,0,1] neg_lo:[0,0,1] neg_hi:[0,0,1]
    v_cvt_pk_bf16_f32 v14, v160, v161
    v_cvt_pk_bf16_f32 v15, v162, v163
    v_cvt_pk_bf16_f32 v16, v176, v177
    v_cvt_pk_bf16_f32 v17, v178, v179
    ds_write_b128 v2, v[14:17] offset:4608
    v_pk_fma_f32 v[164:165], v[164:165], v[28:29], v[28:29] op_sel:[0,0,1] op_sel_hi:[1,0,1] neg_lo:[0,0,1] neg_hi:[0,0,1]
    v_pk_fma_f32 v[166:167], v[166:167], v[28:29], v[28:29] op_sel:[0,0,1] op_sel_hi:[1,0,1] neg_lo:[0,0,1] neg_hi:[0,0,1]
    v_pk_fma_f32 v[180:181], v[180:181], v[28:29], v[28:29] op_sel:[0,0,1] op_sel_hi:[1,0,1] neg_lo:[0,0,1] neg_hi:[0,0,1]
    v_pk_fma_f32 v[182:183], v[182:183], v[28:29], v[28:29] op_sel:[0,0,1] op_sel_hi:[1,0,1] neg_lo:[0,0,1] neg_hi:[0,0,1]
    v_cvt_pk_bf16_f32 v42, v164, v165
    v_cvt_pk_bf16_f32 v43, v166, v167
    v_cvt_pk_bf16_f32 v44, v180, v181
    v_cvt_pk_bf16_f32 v45, v182, v183
    ds_write_b128 v2, v[42:45] offset:29184
    v_pk_fma_f32 v[168:169], v[168:169], v[30:31], v[30:31] op_sel:[0,0,1] op_sel_hi:[1,0,1] neg_lo:[0,0,1] neg_hi:[0,0,1]
    v_pk_fma_f32 v[170:171], v[170:171], v[30:31], v[30:31] op_sel:[0,0,1] op_sel_hi:[1,0,1] neg_lo:[0,0,1] neg_hi:[0,0,1]
    v_pk_fma_f32 v[184:185], v[184:185], v[30:31], v[30:31] op_sel:[0,0,1] op_sel_hi:[1,0,1] neg_lo:[0,0,1] neg_hi:[0,0,1]
    v_pk_fma_f32 v[186:187], v[186:187], v[30:31], v[30:31] op_sel:[0,0,1] op_sel_hi:[1,0,1] neg_lo:[0,0,1] neg_hi:[0,0,1]
    v_cvt_pk_bf16_f32 v46, v168, v169
    v_cvt_pk_bf16_f32 v47, v170, v171
    v_cvt_pk_bf16_f32 v48, v184, v185
    v_cvt_pk_bf16_f32 v49, v186, v187
    ds_write_b128 v19, v[46:49] offset:4608
    v_pk_fma_f32 v[172:173], v[172:173], v[32:33], v[32:33] op_sel:[0,0,1] op_sel_hi:[1,0,1] neg_lo:[0,0,1] neg_hi:[0,0,1]
    v_pk_fma_f32 v[174:175], v[174:175], v[32:33], v[32:33] op_sel:[0,0,1] op_sel_hi:[1,0,1] neg_lo:[0,0,1] neg_hi:[0,0,1]
    v_pk_fma_f32 v[188:189], v[188:189], v[32:33], v[32:33] op_sel:[0,0,1] op_sel_hi:[1,0,1] neg_lo:[0,0,1] neg_hi:[0,0,1]
    v_pk_fma_f32 v[190:191], v[190:191], v[32:33], v[32:33] op_sel:[0,0,1] op_sel_hi:[1,0,1] neg_lo:[0,0,1] neg_hi:[0,0,1]
    v_cvt_pk_bf16_f32 v4, v172, v173
    v_cvt_pk_bf16_f32 v5, v174, v175
    v_cvt_pk_bf16_f32 v6, v188, v189
    v_cvt_pk_bf16_f32 v7, v190, v191
    ds_write_b128 v19, v[4:7] offset:29184
    v_pk_fma_f32 v[192:193], v[192:193], v[26:27], v[26:27] op_sel:[0,0,1] op_sel_hi:[1,0,1] neg_lo:[0,0,1] neg_hi:[0,0,1]
    v_pk_fma_f32 v[194:195], v[194:195], v[26:27], v[26:27] op_sel:[0,0,1] op_sel_hi:[1,0,1] neg_lo:[0,0,1] neg_hi:[0,0,1]
    v_pk_fma_f32 v[208:209], v[208:209], v[26:27], v[26:27] op_sel:[0,0,1] op_sel_hi:[1,0,1] neg_lo:[0,0,1] neg_hi:[0,0,1]
    v_pk_fma_f32 v[210:211], v[210:211], v[26:27], v[26:27] op_sel:[0,0,1] op_sel_hi:[1,0,1] neg_lo:[0,0,1] neg_hi:[0,0,1]
    v_cvt_pk_bf16_f32 v8, v192, v193
    v_cvt_pk_bf16_f32 v9, v194, v195
    v_cvt_pk_bf16_f32 v10, v208, v209
    v_cvt_pk_bf16_f32 v11, v210, v211
    ds_write_b128 v2, v[8:11] offset:8192
    v_pk_fma_f32 v[196:197], v[196:197], v[28:29], v[28:29] op_sel:[0,0,1] op_sel_hi:[1,0,1] neg_lo:[0,0,1] neg_hi:[0,0,1]
    v_pk_fma_f32 v[198:199], v[198:199], v[28:29], v[28:29] op_sel:[0,0,1] op_sel_hi:[1,0,1] neg_lo:[0,0,1] neg_hi:[0,0,1]
    v_pk_fma_f32 v[212:213], v[212:213], v[28:29], v[28:29] op_sel:[0,0,1] op_sel_hi:[1,0,1] neg_lo:[0,0,1] neg_hi:[0,0,1]
    v_pk_fma_f32 v[214:215], v[214:215], v[28:29], v[28:29] op_sel:[0,0,1] op_sel_hi:[1,0,1] neg_lo:[0,0,1] neg_hi:[0,0,1]
    v_cvt_pk_bf16_f32 v14, v196, v197
    v_cvt_pk_bf16_f32 v15, v198, v199
    v_cvt_pk_bf16_f32 v16, v212, v213
    v_cvt_pk_bf16_f32 v17, v214, v215
    ds_write_b128 v2, v[14:17] offset:32768
    v_pk_fma_f32 v[200:201], v[200:201], v[30:31], v[30:31] op_sel:[0,0,1] op_sel_hi:[1,0,1] neg_lo:[0,0,1] neg_hi:[0,0,1]
    v_pk_fma_f32 v[202:203], v[202:203], v[30:31], v[30:31] op_sel:[0,0,1] op_sel_hi:[1,0,1] neg_lo:[0,0,1] neg_hi:[0,0,1]
    v_pk_fma_f32 v[216:217], v[216:217], v[30:31], v[30:31] op_sel:[0,0,1] op_sel_hi:[1,0,1] neg_lo:[0,0,1] neg_hi:[0,0,1]
    v_pk_fma_f32 v[218:219], v[218:219], v[30:31], v[30:31] op_sel:[0,0,1] op_sel_hi:[1,0,1] neg_lo:[0,0,1] neg_hi:[0,0,1]
    v_cvt_pk_bf16_f32 v42, v200, v201
    v_cvt_pk_bf16_f32 v43, v202, v203
    v_cvt_pk_bf16_f32 v44, v216, v217
    v_cvt_pk_bf16_f32 v45, v218, v219
    ds_write_b128 v19, v[42:45] offset:8192
    v_pk_fma_f32 v[204:205], v[204:205], v[32:33], v[32:33] op_sel:[0,0,1] op_sel_hi:[1,0,1] neg_lo:[0,0,1] neg_hi:[0,0,1]
    v_pk_fma_f32 v[206:207], v[206:207], v[32:33], v[32:33] op_sel:[0,0,1] op_sel_hi:[1,0,1] neg_lo:[0,0,1] neg_hi:[0,0,1]
    v_pk_fma_f32 v[220:221], v[220:221], v[32:33], v[32:33] op_sel:[0,0,1] op_sel_hi:[1,0,1] neg_lo:[0,0,1] neg_hi:[0,0,1]
    v_pk_fma_f32 v[222:223], v[222:223], v[32:33], v[32:33] op_sel:[0,0,1] op_sel_hi:[1,0,1] neg_lo:[0,0,1] neg_hi:[0,0,1]
    v_cvt_pk_bf16_f32 v46, v204, v205
    v_cvt_pk_bf16_f32 v47, v206, v207
    v_cvt_pk_bf16_f32 v48, v220, v221
    v_cvt_pk_bf16_f32 v49, v222, v223
    ds_write_b128 v19, v[46:49] offset:32768
    v_pk_fma_f32 v[224:225], v[224:225], v[26:27], v[26:27] op_sel:[0,0,1] op_sel_hi:[1,0,1] neg_lo:[0,0,1] neg_hi:[0,0,1]
    v_pk_fma_f32 v[226:227], v[226:227], v[26:27], v[26:27] op_sel:[0,0,1] op_sel_hi:[1,0,1] neg_lo:[0,0,1] neg_hi:[0,0,1]
    v_pk_fma_f32 v[240:241], v[240:241], v[26:27], v[26:27] op_sel:[0,0,1] op_sel_hi:[1,0,1] neg_lo:[0,0,1] neg_hi:[0,0,1]
    v_pk_fma_f32 v[242:243], v[242:243], v[26:27], v[26:27] op_sel:[0,0,1] op_sel_hi:[1,0,1] neg_lo:[0,0,1] neg_hi:[0,0,1]
    v_cvt_pk_bf16_f32 v4, v224, v225
    v_cvt_pk_bf16_f32 v5, v226, v227
    v_cvt_pk_bf16_f32 v6, v240, v241
    v_cvt_pk_bf16_f32 v7, v242, v243
    ds_write_b128 v2, v[4:7] offset:8704
    v_pk_fma_f32 v[228:229], v[228:229], v[28:29], v[28:29] op_sel:[0,0,1] op_sel_hi:[1,0,1] neg_lo:[0,0,1] neg_hi:[0,0,1]
    v_pk_fma_f32 v[230:231], v[230:231], v[28:29], v[28:29] op_sel:[0,0,1] op_sel_hi:[1,0,1] neg_lo:[0,0,1] neg_hi:[0,0,1]
    v_pk_fma_f32 v[244:245], v[244:245], v[28:29], v[28:29] op_sel:[0,0,1] op_sel_hi:[1,0,1] neg_lo:[0,0,1] neg_hi:[0,0,1]
    v_pk_fma_f32 v[246:247], v[246:247], v[28:29], v[28:29] op_sel:[0,0,1] op_sel_hi:[1,0,1] neg_lo:[0,0,1] neg_hi:[0,0,1]
    v_cvt_pk_bf16_f32 v8, v228, v229
    v_cvt_pk_bf16_f32 v9, v230, v231
    v_cvt_pk_bf16_f32 v10, v244, v245
    v_cvt_pk_bf16_f32 v11, v246, v247
    ds_write_b128 v2, v[8:11] offset:33280
    v_pk_fma_f32 v[232:233], v[232:233], v[30:31], v[30:31] op_sel:[0,0,1] op_sel_hi:[1,0,1] neg_lo:[0,0,1] neg_hi:[0,0,1]
    v_pk_fma_f32 v[234:235], v[234:235], v[30:31], v[30:31] op_sel:[0,0,1] op_sel_hi:[1,0,1] neg_lo:[0,0,1] neg_hi:[0,0,1]
    v_pk_fma_f32 v[248:249], v[248:249], v[30:31], v[30:31] op_sel:[0,0,1] op_sel_hi:[1,0,1] neg_lo:[0,0,1] neg_hi:[0,0,1]
    v_pk_fma_f32 v[250:251], v[250:251], v[30:31], v[30:31] op_sel:[0,0,1] op_sel_hi:[1,0,1] neg_lo:[0,0,1] neg_hi:[0,0,1]
    v_cvt_pk_bf16_f32 v14, v232, v233
    v_cvt_pk_bf16_f32 v15, v234, v235
    v_cvt_pk_bf16_f32 v16, v248, v249
    v_cvt_pk_bf16_f32 v17, v250, v251
    ds_write_b128 v19, v[14:17] offset:8704
    v_pk_fma_f32 v[236:237], v[236:237], v[32:33], v[32:33] op_sel:[0,0,1] op_sel_hi:[1,0,1] neg_lo:[0,0,1] neg_hi:[0,0,1]
    v_pk_fma_f32 v[238:239], v[238:239], v[32:33], v[32:33] op_sel:[0,0,1] op_sel_hi:[1,0,1] neg_lo:[0,0,1] neg_hi:[0,0,1]
    v_pk_fma_f32 v[252:253], v[252:253], v[32:33], v[32:33] op_sel:[0,0,1] op_sel_hi:[1,0,1] neg_lo:[0,0,1] neg_hi:[0,0,1]
    v_pk_fma_f32 v[254:255], v[254:255], v[32:33], v[32:33] op_sel:[0,0,1] op_sel_hi:[1,0,1] neg_lo:[0,0,1] neg_hi:[0,0,1]
    v_cvt_pk_bf16_f32 v42, v236, v237
    v_cvt_pk_bf16_f32 v43, v238, v239
    v_cvt_pk_bf16_f32 v44, v252, v253
    v_cvt_pk_bf16_f32 v45, v254, v255
    ds_write_b128 v19, v[42:45] offset:33280
    s_waitcnt lgkmcnt(0)
    s_barrier
    ds_read_b128 a[192:195], v1 offset:0
    ds_read_b64_tr_b16 v[224:225], v50 offset:0
    ds_read_b64_tr_b16 v[226:227], v50 offset:512
    ds_read_b128 a[200:203], v1 offset:1024
    ds_read_b64_tr_b16 v[228:229], v50 offset:2048
    ds_read_b64_tr_b16 v[230:231], v50 offset:2560
    ds_read_b128 a[208:211], v1 offset:2048
    ds_read_b64_tr_b16 v[232:233], v50 offset:4096
    ds_read_b64_tr_b16 v[234:235], v50 offset:4608
    v_mfma_f32_32x32x16_bf16 v[64:79], v[34:37], a[64:67], 0
    ds_read_b128 a[216:219], v1 offset:3072
    ds_read_b64_tr_b16 v[236:237], v50 offset:6144
    ds_read_b64_tr_b16 v[238:239], v50 offset:6656
    v_mfma_f32_32x32x16_bf16 v[64:79], v[38:41], a[68:71], v[64:79]
    ds_read_b128 a[224:227], v1 offset:4096
    ds_read_b64_tr_b16 v[240:241], v50 offset:8192
    v_mfma_f32_32x32x16_bf16 v[80:95], v[34:37], a[72:75], 0
    s_add_u32 m0, s63, 98304
    s_nop 0
    buffer_load_dwordx4 v59, s[84:87], s64 offen offset:0 sc1 lds
    v_mfma_f32_32x32x16_bf16 v[80:95], v[38:41], a[76:79], v[80:95]
    buffer_load_dwordx4 v59, s[84:87], s64 offen offset:1024 sc1 lds
    v_mfma_f32_32x32x16_bf16 v[96:111], v[34:37], a[80:83], 0
    buffer_load_dwordx4 v59, s[84:87], s64 offen offset:2048 sc1 lds
    v_mfma_f32_32x32x16_bf16 v[96:111], v[38:41], a[84:87], v[96:111]
    s_waitcnt lgkmcnt(11)
    ds_read_b64_tr_b16 v[242:243], v50 offset:8704
    ds_read_b128 a[96:99], v1 offset:5120
    ds_read_b64_tr_b16 v[244:245], v50 offset:10240
    v_mfma_f32_32x32x16_bf16 v[192:207], v[224:227], a[192:195], 0
    s_waitcnt lgkmcnt(11)
    ds_read_b64_tr_b16 v[246:247], v50 offset:10752
    ds_read_b128 a[104:107], v1 offset:6144
    ds_read_b64_tr_b16 v[248:249], v50 offset:12288
    v_mfma_f32_32x32x16_bf16 v[192:207], v[228:231], a[200:203], v[192:207]
    s_waitcnt lgkmcnt(11)
    ds_read_b64_tr_b16 v[250:251], v50 offset:12800
    ds_read_b128 a[112:115], v1 offset:7168
    ds_read_b64_tr_b16 v[252:253], v50 offset:14336
    v_mfma_f32_32x32x16_bf16 v[192:207], v[232:235], a[208:211], v[192:207]
    s_waitcnt lgkmcnt(11)
    ds_read_b64_tr_b16 v[254:255], v50 offset:14848
    ds_read_b128 a[120:123], v1 offset:8192
    ds_read_b64_tr_b16 v[12:13], v50 offset:16384
    v_mfma_f32_32x32x16_bf16 v[192:207], v[236:239], a[216:219], v[192:207]
    s_waitcnt lgkmcnt(11)
    ds_read_b64_tr_b16 v[14:15], v50 offset:16896
    ds_read_b128 a[160:163], v1 offset:9216
    ds_read_b64_tr_b16 v[16:17], v50 offset:18432
    v_mfma_f32_32x32x16_bf16 v[192:207], v[240:243], a[224:227], v[192:207]
    s_waitcnt lgkmcnt(11)
    ds_read_b64_tr_b16 v[18:19], v50 offset:18944
    ds_read_b128 a[168:171], v1 offset:10240
    ds_read_b64_tr_b16 v[26:27], v50 offset:20480
    v_mfma_f32_32x32x16_bf16 v[192:207], v[244:247], a[96:99], v[192:207]
    s_waitcnt lgkmcnt(11)
    ds_read_b64_tr_b16 v[28:29], v50 offset:20992
    ds_read_b128 a[176:179], v1 offset:11264
    ds_read_b64_tr_b16 v[30:31], v50 offset:22528
    v_mfma_f32_32x32x16_bf16 v[192:207], v[248:251], a[104:107], v[192:207]
    s_waitcnt lgkmcnt(11)
    ds_read_b64_tr_b16 v[32:33], v50 offset:23040
    ds_read_b128 a[196:199], v1 offset:12288
    ds_read_b128 a[204:207], v1 offset:13312
    v_mfma_f32_32x32x16_bf16 v[192:207], v[252:255], a[112:115], v[192:207]
    s_waitcnt lgkmcnt(11)
    ds_read_b128 a[212:215], v1 offset:14336
    ds_read_b128 a[220:223], v1 offset:15360
    ds_read_b128 a[228:231], v1 offset:16384
    v_mfma_f32_32x32x16_bf16 v[192:207], v[12:15], a[120:123], v[192:207]
    s_waitcnt lgkmcnt(11)
    ds_read_b128 a[100:103], v1 offset:17408
    ds_read_b128 a[108:111], v1 offset:18432
    ds_read_b128 a[116:119], v1 offset:19456
    v_mfma_f32_32x32x16_bf16 v[192:207], v[16:19], a[160:163], v[192:207]
    s_waitcnt lgkmcnt(11)
    ds_read_b128 a[124:127], v1 offset:20480
    ds_read_b128 a[164:167], v1 offset:21504
    ds_read_b128 a[172:175], v1 offset:22528
    v_mfma_f32_32x32x16_bf16 v[192:207], v[26:29], a[168:171], v[192:207]
    s_waitcnt lgkmcnt(11)
    ds_read_b128 a[180:183], v1 offset:23552
    ds_read_b64_tr_b16 a[232:233], v51 offset:0
    ds_read_b64_tr_b16 a[234:235], v51 offset:512
    v_mfma_f32_32x32x16_bf16 v[192:207], v[30:33], a[176:179], v[192:207]
    s_waitcnt lgkmcnt(13)
    ds_read_b64_tr_b16 a[236:237], v51 offset:2048
    s_add_u32 m0, s63, 101376
    s_nop 0
    buffer_load_dwordx4 v59, s[84:87], s65 offen offset:0 sc1 lds
    v_mfma_f32_32x32x16_bf16 v[208:223], v[224:227], a[196:199], 0
    buffer_load_dwordx4 v59, s[84:87], s65 offen offset:1024 sc1 lds
    v_mfma_f32_32x32x16_bf16 v[112:127], v[34:37], a[88:91], 0
    s_waitcnt lgkmcnt(13)
    ds_read_b64_tr_b16 a[238:239], v51 offset:2560
    buffer_load_dwordx4 v59, s[84:87], s65 offen offset:2048 sc1 lds
    v_mfma_f32_32x32x16_bf16 v[208:223], v[228:231], a[204:207], v[208:223]
    s_waitcnt lgkmcnt(4)
    s_barrier
    v_cvt_pk_f16_f32 v22, v192, v193
    v_pk_fma_f16 v42, v22, v22, s60
    v_cvt_pk_f16_f32 v23, v194, v195
    v_pk_mul_f16 v42, v22, v42
    v_pk_fma_f16 v43, v23, v23, s60
    v_cvt_pk_f16_f32 v24, v196, v197
    v_mfma_f32_32x32x16_bf16 v[112:127], v[38:41], a[92:95], v[112:127]
    ds_read_b64_tr_b16 a[240:241], v51 offset:4096
    v_exp_f16_sdwa v42, v42 dst_sel:WORD_0 dst_unused:UNUSED_PRESERVE src0_sel:WORD_0
    v_pk_mul_f16 v43, v23, v43
    v_pk_fma_f16 v44, v24, v24, s60
    v_cvt_pk_f16_f32 v22, v198, v199
    v_mfma_f32_32x32x16_bf16 v[208:223], v[232:235], a[212:215], v[208:223]
    ds_read_b64_tr_b16 a[242:243], v51 offset:4608
    s_add_u32 m0, s63, 0
    s_nop 0
    buffer_load_dwordx4 v59, s[84:87], s66 offen offset:0 sc1 lds
    v_mfma_f32_32x32x16_bf16 v[128:143], v[34:37], a[128:131], 0
    v_exp_f16_sdwa v42, v42 dst_sel:WORD_1 dst_unused:UNUSED_PRESERVE src0_sel:WORD_1
    v_exp_f16_sdwa v43, v43 dst_sel:WORD_0 dst_unused:UNUSED_PRESERVE src0_sel:WORD_0
    v_pk_mul_f16 v44, v24, v44
    v_pk_fma_f16 v45, v22, v22, s60
    v_mfma_f32_32x32x16_bf16 v[208:223], v[236:239], a[220:223], v[208:223]
    buffer_load_dwordx4 v59, s[84:87], s66 offen offset:1024 sc1 lds
    v_mfma_f32_32x32x16_bf16 v[128:143], v[38:41], a[132:135], v[128:143]
    v_cvt_pk_f16_f32 v23, v200, v201
    v_pk_fma_f16 v42, v42, s59, s59
    v_exp_f16_sdwa v43, v43 dst_sel:WORD_1 dst_unused:UNUSED_PRESERVE src0_sel:WORD_1
    v_exp_f16_sdwa v44, v44 dst_sel:WORD_0 dst_unused:UNUSED_PRESERVE src0_sel:WORD_0
    v_mfma_f32_32x32x16_bf16 v[208:223], v[240:243], a[228:231], v[208:223]
    buffer_load_dwordx4 v59, s[84:87], s66 offen offset:2048 sc1 lds
    v_mfma_f32_32x32x16_bf16 v[144:159], v[34:37], a[136:139], 0
    v_pk_mul_f16 v45, v22, v45
    v_pk_fma_f16 v46, v23, v23, s60
    v_cvt_pk_f16_f32 v24, v202, v203
    v_rcp_f16_sdwa v42, v42 dst_sel:WORD_0 dst_unused:UNUSED_PRESERVE src0_sel:WORD_0
    v_pk_fma_f16 v43, v43, s59, s59
    v_mfma_f32_32x32x16_bf16 v[208:223], v[244:247], a[100:103], v[208:223]
    s_add_u32 m0, s63, 3072
    s_nop 0
    buffer_load_dwordx4 v59, s[84:87], s67 offen offset:0 sc1 lds
    v_mfma_f32_32x32x16_bf16 v[144:159], v[38:41], a[140:143], v[144:159]
    v_exp_f16_sdwa v44, v44 dst_sel:WORD_1 dst_unused:UNUSED_PRESERVE src0_sel:WORD_1
    v_exp_f16_sdwa v45, v45 dst_sel:WORD_0 dst_unused:UNUSED_PRESERVE src0_sel:WORD_0
    v_pk_mul_f16 v46, v23, v46
    v_pk_fma_f16 v47, v24, v24, s60
    v_mfma_f32_32x32x16_bf16 v[208:223], v[248:251], a[108:111], v[208:223]
    buffer_load_dwordx4 v59, s[84:87], s67 offen offset:1024 sc1 lds
    v_mfma_f32_32x32x16_bf16 v[160:175], v[34:37], a[144:147], 0
    v_cvt_pk_f16_f32 v22, v204, v205
    v_rcp_f16_sdwa v42, v42 dst_sel:WORD_1 dst_unused:UNUSED_PRESERVE src0_sel:WORD_1
    v_rcp_f16_sdwa v43, v43 dst_sel:WORD_0 dst_unused:UNUSED_PRESERVE src0_sel:WORD_0
    v_pk_fma_f16 v44, v44, s59, s59
    v_mfma_f32_32x32x16_bf16 v[208:223], v[252:255], a[116:119], v[208:223]
    buffer_load_dwordx4 v59, s[84:87], s67 offen offset:2048 sc1 lds
    v_mfma_f32_32x32x16_bf16 v[160:175], v[38:41], a[148:151], v[160:175]
    v_exp_f16_sdwa v45, v45 dst_sel:WORD_1 dst_unused:UNUSED_PRESERVE src0_sel:WORD_1
    v_exp_f16_sdwa v46, v46 dst_sel:WORD_0 dst_unused:UNUSED_PRESERVE src0_sel:WORD_0
    v_pk_mul_f16 v47, v24, v47
    v_pk_fma_f16 v48, v22, v22, s60
    v_mfma_f32_32x32x16_bf16 v[208:223], v[12:15], a[124:127], v[208:223]
    v_cvt_pk_f16_f32 v23, v206, v207
    v_fma_mix_f32 v192, v192, v42, 0 op_sel:[0,0,0] op_sel_hi:[0,1,0]
    v_fma_mix_f32 v193, v193, v42, 0 op_sel:[0,1,0] op_sel_hi:[0,1,0]
    v_rcp_f16_sdwa v43, v43 dst_sel:WORD_1 dst_unused:UNUSED_PRESERVE src0_sel:WORD_1
    v_rcp_f16_sdwa v44, v44 dst_sel:WORD_0 dst_unused:UNUSED_PRESERVE src0_sel:WORD_0
    v_mfma_f32_32x32x16_bf16 v[176:191], v[34:37], a[152:155], 0
    v_pk_fma_f16 v45, v45, s59, s59
    v_exp_f16_sdwa v46, v46 dst_sel:WORD_1 dst_unused:UNUSED_PRESERVE src0_sel:WORD_1
    v_exp_f16_sdwa v47, v47 dst_sel:WORD_0 dst_unused:UNUSED_PRESERVE src0_sel:WORD_0
    v_pk_mul_f16 v48, v22, v48
    v_mfma_f32_32x32x16_bf16 v[208:223], v[16:19], a[164:167], v[208:223]
    v_pk_fma_f16 v49, v23, v23, s60
    v_cvt_pk_bf16_f32 v4, v192, v193
    v_fma_mix_f32 v194, v194, v43, 0 op_sel:[0,0,0] op_sel_hi:[0,1,0]
    v_fma_mix_f32 v195, v195, v43, 0 op_sel:[0,1,0] op_sel_hi:[0,1,0]
    v_rcp_f16_sdwa v44, v44 dst_sel:WORD_1 dst_unused:UNUSED_PRESERVE src0_sel:WORD_1
    v_mfma_f32_32x32x16_bf16 v[176:191], v[38:41], a[156:159], v[176:191]
    v_rcp_f16_sdwa v45, v45 dst_sel:WORD_0 dst_unused:UNUSED_PRESERVE src0_sel:WORD_0
    v_pk_fma_f16 v46, v46, s59, s59
    v_exp_f16_sdwa v47, v47 dst_sel:WORD_1 dst_unused:UNUSED_PRESERVE src0_sel:WORD_1
    v_exp_f16_sdwa v48, v48 dst_sel:WORD_0 dst_unused:UNUSED_PRESERVE src0_sel:WORD_0
    v_mfma_f32_32x32x16_bf16 v[208:223], v[26:29], a[172:175], v[208:223]
    v_pk_mul_f16 v49, v23, v49
    v_cvt_pk_bf16_f32 v5, v194, v195
    v_fma_mix_f32 v196, v196, v44, 0 op_sel:[0,0,0] op_sel_hi:[0,1,0]
    v_fma_mix_f32 v197, v197, v44, 0 op_sel:[0,1,0] op_sel_hi:[0,1,0]
    v_rcp_f16_sdwa v45, v45 dst_sel:WORD_1 dst_unused:UNUSED_PRESERVE src0_sel:WORD_1
    v_mfma_f32_32x32x16_bf16 v[208:223], v[30:33], a[180:183], v[208:223]
    v_rcp_f16_sdwa v46, v46 dst_sel:WORD_0 dst_unused:UNUSED_PRESERVE src0_sel:WORD_0
    v_pk_fma_f16 v47, v47, s59, s59
    v_exp_f16_sdwa v48, v48 dst_sel:WORD_1 dst_unused:UNUSED_PRESERVE src0_sel:WORD_1
    v_exp_f16_sdwa v49, v49 dst_sel:WORD_0 dst_unused:UNUSED_PRESERVE src0_sel:WORD_0
    s_waitcnt lgkmcnt(4)
    v_mfma_f32_32x32x16_bf16 v[224:239], a[232:235], a[192:195], 0
    ds_read_b64_tr_b16 a[244:245], v51 offset:6144
    ds_read_b64_tr_b16 a[246:247], v51 offset:6656
    v_cvt_pk_bf16_f32 v6, v196, v197
    v_fma_mix_f32 v198, v198, v45, 0 op_sel:[0,0,0] op_sel_hi:[0,1,0]
    v_fma_mix_f32 v199, v199, v45, 0 op_sel:[0,1,0] op_sel_hi:[0,1,0]
    v_rcp_f16_sdwa v46, v46 dst_sel:WORD_1 dst_unused:UNUSED_PRESERVE src0_sel:WORD_1
    v_mfma_f32_32x32x16_bf16 v[240:255], a[232:235], a[196:199], 0
    s_waitcnt lgkmcnt(4)
    s_add_u32 s64, s64, 24576
    s_add_u32 s65, s65, 24576
    s_add_u32 s66, s66, 24576
    s_add_u32 s67, s67, 24576
    v_rcp_f16_sdwa v47, v47 dst_sel:WORD_0 dst_unused:UNUSED_PRESERVE src0_sel:WORD_0
    v_pk_fma_f16 v48, v48, s59, s59
    v_mfma_f32_32x32x16_bf16 v[224:239], a[236:239], a[200:203], v[224:239]
    ds_read_b64_tr_b16 a[248:249], v51 offset:8192
    ds_read_b64_tr_b16 a[250:251], v51 offset:8704
    s_add_u32 s63, s63, s62
    s_mov_b32 s68, 11
    v_exp_f16_sdwa v49, v49 dst_sel:WORD_1 dst_unused:UNUSED_PRESERVE src0_sel:WORD_1
    v_cvt_pk_bf16_f32 v7, v198, v199
    v_fma_mix_f32 v200, v200, v46, 0 op_sel:[0,0,0] op_sel_hi:[0,1,0]
    v_mfma_f32_32x32x16_bf16 v[240:255], a[236:239], a[204:207], v[240:255]
    s_waitcnt lgkmcnt(4)
    v_fma_mix_f32 v201, v201, v46, 0 op_sel:[0,1,0] op_sel_hi:[0,1,0]
    v_rcp_f16_sdwa v47, v47 dst_sel:WORD_1 dst_unused:UNUSED_PRESERVE src0_sel:WORD_1
    v_rcp_f16_sdwa v48, v48 dst_sel:WORD_0 dst_unused:UNUSED_PRESERVE src0_sel:WORD_0
    v_pk_fma_f16 v49, v49, s59, s59
    v_cvt_pk_bf16_f32 v8, v200, v201
    v_fma_mix_f32 v202, v202, v47, 0 op_sel:[0,0,0] op_sel_hi:[0,1,0]
    v_mfma_f32_32x32x16_bf16 v[224:239], a[240:243], a[208:211], v[224:239]
    ds_read_b64_tr_b16 a[252:253], v51 offset:10240
    ds_read_b64_tr_b16 a[254:255], v51 offset:10752
    v_fma_mix_f32 v203, v203, v47, 0 op_sel:[0,1,0] op_sel_hi:[0,1,0]
    v_rcp_f16_sdwa v48, v48 dst_sel:WORD_1 dst_unused:UNUSED_PRESERVE src0_sel:WORD_1
    v_rcp_f16_sdwa v49, v49 dst_sel:WORD_0 dst_unused:UNUSED_PRESERVE src0_sel:WORD_0
    v_cvt_pk_bf16_f32 v9, v202, v203
    v_mfma_f32_32x32x16_bf16 v[240:255], a[240:243], a[212:215], v[240:255]
    s_waitcnt lgkmcnt(4)
    v_fma_mix_f32 v204, v204, v48, 0 op_sel:[0,0,0] op_sel_hi:[0,1,0]
    v_fma_mix_f32 v205, v205, v48, 0 op_sel:[0,1,0] op_sel_hi:[0,1,0]
    v_rcp_f16_sdwa v49, v49 dst_sel:WORD_1 dst_unused:UNUSED_PRESERVE src0_sel:WORD_1
    v_cvt_pk_bf16_f32 v10, v204, v205
    v_fma_mix_f32 v206, v206, v49, 0 op_sel:[0,0,0] op_sel_hi:[0,1,0]
    v_fma_mix_f32 v207, v207, v49, 0 op_sel:[0,1,0] op_sel_hi:[0,1,0]
    v_cvt_pk_bf16_f32 v11, v206, v207
    v_mfma_f32_32x32x16_bf16 v[224:239], a[244:247], a[216:219], v[224:239]
    ds_read_b64_tr_b16 a[232:233], v51 offset:12288
    ds_read_b64_tr_b16 a[234:235], v51 offset:12800
    v_cvt_pk_f16_f32 v22, v208, v209
    v_pk_fma_f16 v42, v22, v22, s60
    v_cvt_pk_f16_f32 v23, v210, v211
    v_pk_mul_f16 v42, v22, v42
    v_pk_fma_f16 v43, v23, v23, s60
    v_cvt_pk_f16_f32 v24, v212, v213
    v_mfma_f32_32x32x16_bf16 v[240:255], a[244:247], a[220:223], v[240:255]
    s_waitcnt lgkmcnt(4)
    v_exp_f16_sdwa v42, v42 dst_sel:WORD_0 dst_unused:UNUSED_PRESERVE src0_sel:WORD_0
    v_pk_mul_f16 v43, v23, v43
    v_pk_fma_f16 v44, v24, v24, s60
    v_cvt_pk_f16_f32 v22, v214, v215
    v_exp_f16_sdwa v42, v42 dst_sel:WORD_1 dst_unused:UNUSED_PRESERVE src0_sel:WORD_1
    v_mfma_f32_32x32x16_bf16 v[224:239], a[248:251], a[224:227], v[224:239]
    ds_read_b64_tr_b16 a[236:237], v51 offset:14336
    ds_read_b64_tr_b16 a[238:239], v51 offset:14848
    v_exp_f16_sdwa v43, v43 dst_sel:WORD_0 dst_unused:UNUSED_PRESERVE src0_sel:WORD_0
    v_pk_mul_f16 v44, v24, v44
    v_pk_fma_f16 v45, v22, v22, s60
    v_cvt_pk_f16_f32 v23, v216, v217
    v_pk_fma_f16 v42, v42, s59, s59
    v_mfma_f32_32x32x16_bf16 v[240:255], a[248:251], a[228:231], v[240:255]
    s_waitcnt lgkmcnt(4)
    v_exp_f16_sdwa v43, v43 dst_sel:WORD_1 dst_unused:UNUSED_PRESERVE src0_sel:WORD_1
    v_exp_f16_sdwa v44, v44 dst_sel:WORD_0 dst_unused:UNUSED_PRESERVE src0_sel:WORD_0
    v_pk_mul_f16 v45, v22, v45
    v_pk_fma_f16 v46, v23, v23, s60
    v_cvt_pk_f16_f32 v24, v218, v219
    v_mfma_f32_32x32x16_bf16 v[224:239], a[252:255], a[96:99], v[224:239]
    ds_read_b64_tr_b16 a[240:241], v51 offset:16384
    ds_read_b64_tr_b16 a[242:243], v51 offset:16896
    v_rcp_f16_sdwa v42, v42 dst_sel:WORD_0 dst_unused:UNUSED_PRESERVE src0_sel:WORD_0
    v_pk_fma_f16 v43, v43, s59, s59
    v_exp_f16_sdwa v44, v44 dst_sel:WORD_1 dst_unused:UNUSED_PRESERVE src0_sel:WORD_1
    v_mfma_f32_32x32x16_bf16 v[240:255], a[252:255], a[100:103], v[240:255]
    s_waitcnt lgkmcnt(4)
    v_exp_f16_sdwa v45, v45 dst_sel:WORD_0 dst_unused:UNUSED_PRESERVE src0_sel:WORD_0
    v_pk_mul_f16 v46, v23, v46
    v_pk_fma_f16 v47, v24, v24, s60
    v_cvt_pk_f16_f32 v22, v220, v221
    v_rcp_f16_sdwa v42, v42 dst_sel:WORD_1 dst_unused:UNUSED_PRESERVE src0_sel:WORD_1
    v_mfma_f32_32x32x16_bf16 v[224:239], a[232:235], a[104:107], v[224:239]
    ds_read_b64_tr_b16 a[244:245], v51 offset:18432
    ds_read_b64_tr_b16 a[246:247], v51 offset:18944
    v_rcp_f16_sdwa v43, v43 dst_sel:WORD_0 dst_unused:UNUSED_PRESERVE src0_sel:WORD_0
    v_pk_fma_f16 v44, v44, s59, s59
    v_exp_f16_sdwa v45, v45 dst_sel:WORD_1 dst_unused:UNUSED_PRESERVE src0_sel:WORD_1
    v_mfma_f32_32x32x16_bf16 v[240:255], a[232:235], a[108:111], v[240:255]
    s_waitcnt lgkmcnt(4)
    v_exp_f16_sdwa v46, v46 dst_sel:WORD_0 dst_unused:UNUSED_PRESERVE src0_sel:WORD_0
    v_pk_mul_f16 v47, v24, v47
    v_pk_fma_f16 v48, v22, v22, s60
    v_cvt_pk_f16_f32 v23, v222, v223
    v_fma_mix_f32 v208, v208, v42, 0 op_sel:[0,0,0] op_sel_hi:[0,1,0]
    v_fma_mix_f32 v209, v209, v42, 0 op_sel:[0,1,0] op_sel_hi:[0,1,0]
    v_mfma_f32_32x32x16_bf16 v[224:239], a[236:239], a[112:115], v[224:239]
    ds_read_b64_tr_b16 a[248:249], v51 offset:20480
    ds_read_b64_tr_b16 a[250:251], v51 offset:20992
    v_rcp_f16_sdwa v43, v43 dst_sel:WORD_1 dst_unused:UNUSED_PRESERVE src0_sel:WORD_1
    v_rcp_f16_sdwa v44, v44 dst_sel:WORD_0 dst_unused:UNUSED_PRESERVE src0_sel:WORD_0
    v_pk_fma_f16 v45, v45, s59, s59
    v_exp_f16_sdwa v46, v46 dst_sel:WORD_1 dst_unused:UNUSED_PRESERVE src0_sel:WORD_1
    v_mfma_f32_32x32x16_bf16 v[240:255], a[236:239], a[116:119], v[240:255]
    s_waitcnt lgkmcnt(4)
    v_exp_f16_sdwa v47, v47 dst_sel:WORD_0 dst_unused:UNUSED_PRESERVE src0_sel:WORD_0
    v_pk_mul_f16 v48, v22, v48
    v_pk_fma_f16 v49, v23, v23, s60
    v_cvt_pk_bf16_f32 v12, v208, v209
    v_fma_mix_f32 v210, v210, v43, 0 op_sel:[0,0,0] op_sel_hi:[0,1,0]
    v_fma_mix_f32 v211, v211, v43, 0 op_sel:[0,1,0] op_sel_hi:[0,1,0]
    v_mfma_f32_32x32x16_bf16 v[224:239], a[240:243], a[120:123], v[224:239]
    s_waitcnt vmcnt(0)
    s_barrier
    ds_read_b64_tr_b16 a[252:253], v51 offset:22528
    ds_read_b64_tr_b16 a[254:255], v51 offset:23040
    v_rcp_f16_sdwa v44, v44 dst_sel:WORD_1 dst_unused:UNUSED_PRESERVE src0_sel:WORD_1
    v_rcp_f16_sdwa v45, v45 dst_sel:WORD_0 dst_unused:UNUSED_PRESERVE src0_sel:WORD_0
    v_mfma_f32_32x32x16_bf16 v[240:255], a[240:243], a[124:127], v[240:255]
    s_waitcnt lgkmcnt(4)
    v_pk_fma_f16 v46, v46, s59, s59
    v_exp_f16_sdwa v47, v47 dst_sel:WORD_1 dst_unused:UNUSED_PRESERVE src0_sel:WORD_1
    v_exp_f16_sdwa v48, v48 dst_sel:WORD_0 dst_unused:UNUSED_PRESERVE src0_sel:WORD_0
    v_pk_mul_f16 v49, v23, v49
    v_cvt_pk_bf16_f32 v13, v210, v211
    v_fma_mix_f32 v212, v212, v44, 0 op_sel:[0,0,0] op_sel_hi:[0,1,0]
    v_mfma_f32_32x32x16_bf16 v[224:239], a[244:247], a[160:163], v[224:239]
    ds_read_b128 a[232:235], v52 offset:0
    ds_read_b128 a[236:239], v52 offset:1024
    v_fma_mix_f32 v213, v213, v44, 0 op_sel:[0,1,0] op_sel_hi:[0,1,0]
    v_rcp_f16_sdwa v45, v45 dst_sel:WORD_1 dst_unused:UNUSED_PRESERVE src0_sel:WORD_1
    v_rcp_f16_sdwa v46, v46 dst_sel:WORD_0 dst_unused:UNUSED_PRESERVE src0_sel:WORD_0
    v_pk_fma_f16 v47, v47, s59, s59
    v_mfma_f32_32x32x16_bf16 v[240:255], a[244:247], a[164:167], v[240:255]
    s_waitcnt lgkmcnt(4)
    v_exp_f16_sdwa v48, v48 dst_sel:WORD_1 dst_unused:UNUSED_PRESERVE src0_sel:WORD_1
    v_exp_f16_sdwa v49, v49 dst_sel:WORD_0 dst_unused:UNUSED_PRESERVE src0_sel:WORD_0
    v_cvt_pk_bf16_f32 v14, v212, v213
    v_fma_mix_f32 v214, v214, v45, 0 op_sel:[0,0,0] op_sel_hi:[0,1,0]
    v_fma_mix_f32 v215, v215, v45, 0 op_sel:[0,1,0] op_sel_hi:[0,1,0]
    v_rcp_f16_sdwa v46, v46 dst_sel:WORD_1 dst_unused:UNUSED_PRESERVE src0_sel:WORD_1
    v_mfma_f32_32x32x16_bf16 v[224:239], a[248:251], a[168:171], v[224:239]
    ds_read_b128 a[240:243], v52 offset:2048
    v_rcp_f16_sdwa v47, v47 dst_sel:WORD_0 dst_unused:UNUSED_PRESERVE src0_sel:WORD_0
    v_pk_fma_f16 v48, v48, s59, s59
    v_exp_f16_sdwa v49, v49 dst_sel:WORD_1 dst_unused:UNUSED_PRESERVE src0_sel:WORD_1
    v_cvt_pk_bf16_f32 v15, v214, v215
    v_fma_mix_f32 v216, v216, v46, 0 op_sel:[0,0,0] op_sel_hi:[0,1,0]
    v_mfma_f32_32x32x16_bf16 v[240:255], a[248:251], a[172:175], v[240:255]
    s_waitcnt lgkmcnt(3)
    v_fma_mix_f32 v217, v217, v46, 0 op_sel:[0,1,0] op_sel_hi:[0,1,0]
    v_rcp_f16_sdwa v47, v47 dst_sel:WORD_1 dst_unused:UNUSED_PRESERVE src0_sel:WORD_1
    v_rcp_f16_sdwa v48, v48 dst_sel:WORD_0 dst_unused:UNUSED_PRESERVE src0_sel:WORD_0
    v_pk_fma_f16 v49, v49, s59, s59
    v_cvt_pk_bf16_f32 v16, v216, v217
    v_fma_mix_f32 v218, v218, v47, 0 op_sel:[0,0,0] op_sel_hi:[0,1,0]
    v_mfma_f32_32x32x16_bf16 v[224:239], a[252:255], a[176:179], v[224:239]
    ds_read_b128 a[244:247], v52 offset:3072
    v_fma_mix_f32 v219, v219, v47, 0 op_sel:[0,1,0] op_sel_hi:[0,1,0]
    v_rcp_f16_sdwa v48, v48 dst_sel:WORD_1 dst_unused:UNUSED_PRESERVE src0_sel:WORD_1
    v_rcp_f16_sdwa v49, v49 dst_sel:WORD_0 dst_unused:UNUSED_PRESERVE src0_sel:WORD_0
    v_cvt_pk_bf16_f32 v17, v218, v219
    v_fma_mix_f32 v220, v220, v48, 0 op_sel:[0,0,0] op_sel_hi:[0,1,0]
    v_mfma_f32_32x32x16_bf16 v[240:255], a[252:255], a[180:183], v[240:255]
    s_waitcnt lgkmcnt(3)
    v_fma_mix_f32 v221, v221, v48, 0 op_sel:[0,1,0] op_sel_hi:[0,1,0]
    v_rcp_f16_sdwa v49, v49 dst_sel:WORD_1 dst_unused:UNUSED_PRESERVE src0_sel:WORD_1
    v_cvt_pk_bf16_f32 v18, v220, v221
    v_fma_mix_f32 v222, v222, v49, 0 op_sel:[0,0,0] op_sel_hi:[0,1,0]
    v_fma_mix_f32 v223, v223, v49, 0 op_sel:[0,1,0] op_sel_hi:[0,1,0]
    v_cvt_pk_bf16_f32 v19, v222, v223
L_loop:
    v_mfma_f32_32x32x16_bf16 v[192:207], a[232:235], a[192:195], 0
    ds_read_b128 a[248:251], v52 offset:4096
    v_cvt_pk_f16_f32 v22, v224, v225
    v_pk_fma_f16 v42, v22, v22, s60
    v_cvt_pk_f16_f32 v23, v226, v227
    v_pk_mul_f16 v42, v22, v42
    v_pk_fma_f16 v43, v23, v23, s60
    v_mfma_f32_32x32x16_bf16 v[208:223], a[232:235], a[196:199], 0
    s_waitcnt lgkmcnt(3)
    v_cvt_pk_f16_f32 v24, v228, v229
    v_exp_f16_sdwa v42, v42 dst_sel:WORD_0 dst_unused:UNUSED_PRESERVE src0_sel:WORD_0
    v_pk_mul_f16 v43, v23, v43
    v_pk_fma_f16 v44, v24, v24, s60
    v_cvt_pk_f16_f32 v22, v230, v231
    v_mfma_f32_32x32x16_bf16 v[192:207], a[236:239], a[200:203], v[192:207]
    s_add_u32 m0, s63, 98304
    ds_read_b128 a[252:255], v52 offset:5120
    v_exp_f16_sdwa v42, v42 dst_sel:WORD_1 dst_unused:UNUSED_PRESERVE src0_sel:WORD_1
    v_exp_f16_sdwa v43, v43 dst_sel:WORD_0 dst_unused:UNUSED_PRESERVE src0_sel:WORD_0
    v_pk_mul_f16 v44, v24, v44
    v_mfma_f32_32x32x16_bf16 v[208:223], a[236:239], a[204:207], v[208:223]
    s_waitcnt lgkmcnt(3)
    buffer_load_dwordx4 v59, s[84:87], s64 offen offset:0 sc1 lds
    v_mfma_f32_32x32x16_bf16 v[192:207], a[240:243], a[208:211], v[192:207]
    ds_read_b128 a[232:235], v52 offset:6144
    v_pk_fma_f16 v45, v22, v22, s60
    v_cvt_pk_f16_f32 v23, v240, v241
    v_pk_fma_f16 v42, v42, s59, s59
    v_exp_f16_sdwa v43, v43 dst_sel:WORD_1 dst_unused:UNUSED_PRESERVE src0_sel:WORD_1
    v_mfma_f32_32x32x16_bf16 v[208:223], a[240:243], a[212:215], v[208:223]
    s_waitcnt lgkmcnt(3)
    v_exp_f16_sdwa v44, v44 dst_sel:WORD_0 dst_unused:UNUSED_PRESERVE src0_sel:WORD_0
    v_pk_mul_f16 v45, v22, v45
    v_pk_fma_f16 v46, v23, v23, s60
    v_cvt_pk_f16_f32 v24, v242, v243
    v_rcp_f16_sdwa v42, v42 dst_sel:WORD_0 dst_unused:UNUSED_PRESERVE src0_sel:WORD_0
    v_mfma_f32_32x32x16_bf16 v[192:207], a[244:247], a[216:219], v[192:207]
    ds_read_b128 a[236:239], v52 offset:7168
    v_pk_fma_f16 v43, v43, s59, s59
    v_exp_f16_sdwa v44, v44 dst_sel:WORD_1 dst_unused:UNUSED_PRESERVE src0_sel:WORD_1
    v_exp_f16_sdwa v45, v45 dst_sel:WORD_0 dst_unused:UNUSED_PRESERVE src0_sel:WORD_0
    v_mfma_f32_32x32x16_bf16 v[208:223], a[244:247], a[220:223], v[208:223]
    s_waitcnt lgkmcnt(3)
    v_pk_mul_f16 v46, v23, v46
    v_pk_fma_f16 v47, v24, v24, s60
    v_cvt_pk_f16_f32 v22, v244, v245
    v_rcp_f16_sdwa v42, v42 dst_sel:WORD_1 dst_unused:UNUSED_PRESERVE src0_sel:WORD_1
    v_rcp_f16_sdwa v43, v43 dst_sel:WORD_0 dst_unused:UNUSED_PRESERVE src0_sel:WORD_0
    v_mfma_f32_32x32x16_bf16 v[192:207], a[248:251], a[224:227], v[192:207]
    ds_read_b128 a[240:243], v52 offset:8192
    v_pk_fma_f16 v44, v44, s59, s59
    v_exp_f16_sdwa v45, v45 dst_sel:WORD_1 dst_unused:UNUSED_PRESERVE src0_sel:WORD_1
    v_exp_f16_sdwa v46, v46 dst_sel:WORD_0 dst_unused:UNUSED_PRESERVE src0_sel:WORD_0
    v_mfma_f32_32x32x16_bf16 v[208:223], a[248:251], a[228:231], v[208:223]
    s_waitcnt lgkmcnt(3)
    buffer_load_dwordx4 v59, s[84:87], s64 offen offset:1024 sc1 lds
    v_mfma_f32_32x32x16_bf16 v[192:207], a[252:255], a[96:99], v[192:207]
    ds_read_b128 a[244:247], v52 offset:9216
    v_pk_mul_f16 v47, v24, v47
    v_pk_fma_f16 v48, v22, v22, s60
    v_cvt_pk_f16_f32 v23, v246, v247
    v_fma_mix_f32 v224, v224, v42, 0 op_sel:[0,0,0] op_sel_hi:[0,1,0]
    v_fma_mix_f32 v225, v225, v42, 0 op_sel:[0,1,0] op_sel_hi:[0,1,0]
    v_mfma_f32_32x32x16_bf16 v[208:223], a[252:255], a[100:103], v[208:223]
    s_waitcnt lgkmcnt(3)
    v_rcp_f16_sdwa v43, v43 dst_sel:WORD_1 dst_unused:UNUSED_PRESERVE src0_sel:WORD_1
    v_rcp_f16_sdwa v44, v44 dst_sel:WORD_0 dst_unused:UNUSED_PRESERVE src0_sel:WORD_0
    v_pk_fma_f16 v45, v45, s59, s59
    v_exp_f16_sdwa v46, v46 dst_sel:WORD_1 dst_unused:UNUSED_PRESERVE src0_sel:WORD_1
    v_mfma_f32_32x32x16_bf16 v[192:207], a[232:235], a[104:107], v[192:207]
    ds_read_b128 a[248:251], v52 offset:10240
    v_exp_f16_sdwa v47, v47 dst_sel:WORD_0 dst_unused:UNUSED_PRESERVE src0_sel:WORD_0
    v_pk_mul_f16 v48, v22, v48
    v_pk_fma_f16 v49, v23, v23, s60
    v_cvt_pk_f16_f32 v24, v232, v233
    v_mfma_f32_32x32x16_bf16 v[208:223], a[232:235], a[108:111], v[208:223]
    s_waitcnt lgkmcnt(3)
    v_cvt_pk_bf16_f32 v26, v224, v225
    v_fma_mix_f32 v226, v226, v43, 0 op_sel:[0,0,0] op_sel_hi:[0,1,0]
    v_fma_mix_f32 v227, v227, v43, 0 op_sel:[0,1,0] op_sel_hi:[0,1,0]
    v_rcp_f16_sdwa v44, v44 dst_sel:WORD_1 dst_unused:UNUSED_PRESERVE src0_sel:WORD_1
    v_rcp_f16_sdwa v45, v45 dst_sel:WORD_0 dst_unused:UNUSED_PRESERVE src0_sel:WORD_0
    v_mfma_f32_32x32x16_bf16 v[192:207], a[236:239], a[112:115], v[192:207]
    ds_read_b128 a[252:255], v52 offset:11264
    v_pk_fma_f16 v46, v46, s59, s59
    v_exp_f16_sdwa v47, v47 dst_sel:WORD_1 dst_unused:UNUSED_PRESERVE src0_sel:WORD_1
    v_exp_f16_sdwa v48, v48 dst_sel:WORD_0 dst_unused:UNUSED_PRESERVE src0_sel:WORD_0
    v_mfma_f32_32x32x16_bf16 v[208:223], a[236:239], a[116:119], v[208:223]
    s_waitcnt lgkmcnt(3)
    buffer_load_dwordx4 v59, s[84:87], s64 offen offset:2048 sc1 lds
    v_mfma_f32_32x32x16_bf16 v[192:207], a[240:243], a[120:123], v[192:207]
    ds_read_b128 a[232:235], v53 offset:0
    v_pk_mul_f16 v49, v23, v49
    v_pk_fma_f16 v20, v24, v24, s60
    v_cvt_pk_f16_f32 v22, v234, v235
    v_cvt_pk_bf16_f32 v27, v226, v227
    v_fma_mix_f32 v228, v228, v44, 0 op_sel:[0,0,0] op_sel_hi:[0,1,0]
    v_fma_mix_f32 v229, v229, v44, 0 op_sel:[0,1,0] op_sel_hi:[0,1,0]
    v_mfma_f32_32x32x16_bf16 v[208:223], a[240:243], a[124:127], v[208:223]
    s_waitcnt lgkmcnt(3)
    v_rcp_f16_sdwa v45, v45 dst_sel:WORD_1 dst_unused:UNUSED_PRESERVE src0_sel:WORD_1
    v_rcp_f16_sdwa v46, v46 dst_sel:WORD_0 dst_unused:UNUSED_PRESERVE src0_sel:WORD_0
    v_pk_fma_f16 v47, v47, s59, s59
    v_exp_f16_sdwa v48, v48 dst_sel:WORD_1 dst_unused:UNUSED_PRESERVE src0_sel:WORD_1
    v_mfma_f32_32x32x16_bf16 v[192:207], a[244:247], a[160:163], v[192:207]
    ds_read_b128 a[236:239], v53 offset:1024
    v_exp_f16_sdwa v49, v49 dst_sel:WORD_0 dst_unused:UNUSED_PRESERVE src0_sel:WORD_0
    v_pk_mul_f16 v20, v24, v20
    v_pk_fma_f16 v21, v22, v22, s60
    v_cvt_pk_f16_f32 v23, v236, v237
    v_mfma_f32_32x32x16_bf16 v[208:223], a[244:247], a[164:167], v[208:223]
    s_waitcnt lgkmcnt(3)
    v_cvt_pk_bf16_f32 v28, v228, v229
    v_fma_mix_f32 v230, v230, v45, 0 op_sel:[0,0,0] op_sel_hi:[0,1,0]
    v_fma_mix_f32 v231, v231, v45, 0 op_sel:[0,1,0] op_sel_hi:[0,1,0]
    v_rcp_f16_sdwa v46, v46 dst_sel:WORD_1 dst_unused:UNUSED_PRESERVE src0_sel:WORD_1
    v_rcp_f16_sdwa v47, v47 dst_sel:WORD_0 dst_unused:UNUSED_PRESERVE src0_sel:WORD_0
    v_mfma_f32_32x32x16_bf16 v[192:207], a[248:251], a[168:171], v[192:207]
    s_add_u32 m0, s63, 101376
    ds_read_b128 a[240:243], v53 offset:2048
    v_pk_fma_f16 v48, v48, s59, s59
    v_exp_f16_sdwa v49, v49 dst_sel:WORD_1 dst_unused:UNUSED_PRESERVE src0_sel:WORD_1
    v_exp_f16_sdwa v20, v20 dst_sel:WORD_0 dst_unused:UNUSED_PRESERVE src0_sel:WORD_0
    v_mfma_f32_32x32x16_bf16 v[208:223], a[248:251], a[172:175], v[208:223]
    s_waitcnt lgkmcnt(3)
    buffer_load_dwordx4 v59, s[84:87], s65 offen offset:0 sc1 lds
    v_mfma_f32_32x32x16_bf16 v[192:207], a[252:255], a[176:179], v[192:207]
    ds_read_b128 a[244:247], v53 offset:3072
    v_pk_mul_f16 v21, v22, v21
    v_pk_fma_f16 v42, v23, v23, s60
    v_cvt_pk_f16_f32 v24, v238, v239
    v_cvt_pk_bf16_f32 v29, v230, v231
    v_fma_mix_f32 v240, v240, v46, 0 op_sel:[0,0,0] op_sel_hi:[0,1,0]
    v_mfma_f32_32x32x16_bf16 v[208:223], a[252:255], a[180:183], v[208:223]
    s_waitcnt lgkmcnt(3)
    v_fma_mix_f32 v241, v241, v46, 0 op_sel:[0,1,0] op_sel_hi:[0,1,0]
    v_rcp_f16_sdwa v47, v47 dst_sel:WORD_1 dst_unused:UNUSED_PRESERVE src0_sel:WORD_1
    v_rcp_f16_sdwa v48, v48 dst_sel:WORD_0 dst_unused:UNUSED_PRESERVE src0_sel:WORD_0
    v_pk_fma_f16 v49, v49, s59, s59
    v_mfma_f32_32x32x16_bf16 a[0:15], a[232:235], v[4:7], a[0:15]
    ds_read_b128 a[248:251], v53 offset:4096
    v_exp_f16_sdwa v20, v20 dst_sel:WORD_1 dst_unused:UNUSED_PRESERVE src0_sel:WORD_1
    v_exp_f16_sdwa v21, v21 dst_sel:WORD_0 dst_unused:UNUSED_PRESERVE src0_sel:WORD_0
    v_pk_mul_f16 v42, v23, v42
    v_pk_fma_f16 v43, v24, v24, s60
    v_mfma_f32_32x32x16_bf16 a[16:31], a[232:235], v[12:15], a[16:31]
    s_waitcnt lgkmcnt(3)
    v_cvt_pk_f16_f32 v22, v248, v249
    v_cvt_pk_bf16_f32 v34, v240, v241
    v_fma_mix_f32 v242, v242, v47, 0 op_sel:[0,0,0] op_sel_hi:[0,1,0]
    v_fma_mix_f32 v243, v243, v47, 0 op_sel:[0,1,0] op_sel_hi:[0,1,0]
    v_rcp_f16_sdwa v48, v48 dst_sel:WORD_1 dst_unused:UNUSED_PRESERVE src0_sel:WORD_1
    v_mfma_f32_32x32x16_bf16 a[32:47], a[236:239], v[4:7], a[32:47]
    ds_read_b128 a[252:255], v53 offset:5120
    v_rcp_f16_sdwa v49, v49 dst_sel:WORD_0 dst_unused:UNUSED_PRESERVE src0_sel:WORD_0
    v_pk_fma_f16 v20, v20, s59, s59
    v_exp_f16_sdwa v21, v21 dst_sel:WORD_1 dst_unused:UNUSED_PRESERVE src0_sel:WORD_1
    v_mfma_f32_32x32x16_bf16 a[48:63], a[236:239], v[12:15], a[48:63]
    s_waitcnt lgkmcnt(3)
    buffer_load_dwordx4 v59, s[84:87], s65 offen offset:1024 sc1 lds
    v_mfma_f32_32x32x16_bf16 v[64:79], a[240:243], v[4:7], v[64:79]
    ds_read_b128 a[232:235], v53 offset:6144
    v_exp_f16_sdwa v42, v42 dst_sel:WORD_0 dst_unused:UNUSED_PRESERVE src0_sel:WORD_0
    v_pk_mul_f16 v43, v24, v43
    v_pk_fma_f16 v44, v22, v22, s60
    v_cvt_pk_f16_f32 v23, v250, v251
    v_cvt_pk_bf16_f32 v35, v242, v243
    v_mfma_f32_32x32x16_bf16 v[80:95], a[240:243], v[12:15], v[80:95]
    s_waitcnt lgkmcnt(3)
    v_fma_mix_f32 v244, v244, v48, 0 op_sel:[0,0,0] op_sel_hi:[0,1,0]
    v_fma_mix_f32 v245, v245, v48, 0 op_sel:[0,1,0] op_sel_hi:[0,1,0]
    v_rcp_f16_sdwa v49, v49 dst_sel:WORD_1 dst_unused:UNUSED_PRESERVE src0_sel:WORD_1
    v_rcp_f16_sdwa v20, v20 dst_sel:WORD_0 dst_unused:UNUSED_PRESERVE src0_sel:WORD_0
    v_pk_fma_f16 v21, v21, s59, s59
    v_mfma_f32_32x32x16_bf16 v[96:111], a[244:247], v[4:7], v[96:111]
    ds_read_b128 a[236:239], v53 offset:7168
    v_exp_f16_sdwa v42, v42 dst_sel:WORD_1 dst_unused:UNUSED_PRESERVE src0_sel:WORD_1
    v_exp_f16_sdwa v43, v43 dst_sel:WORD_0 dst_unused:UNUSED_PRESERVE src0_sel:WORD_0
    v_pk_mul_f16 v44, v22, v44
    v_pk_fma_f16 v45, v23, v23, s60
    v_mfma_f32_32x32x16_bf16 v[112:127], a[244:247], v[12:15], v[112:127]
    s_waitcnt lgkmcnt(3)
    v_cvt_pk_f16_f32 v24, v252, v253
    v_cvt_pk_bf16_f32 v36, v244, v245
    v_fma_mix_f32 v246, v246, v49, 0 op_sel:[0,0,0] op_sel_hi:[0,1,0]
    v_fma_mix_f32 v247, v247, v49, 0 op_sel:[0,1,0] op_sel_hi:[0,1,0]
    v_rcp_f16_sdwa v20, v20 dst_sel:WORD_1 dst_unused:UNUSED_PRESERVE src0_sel:WORD_1
    v_mfma_f32_32x32x16_bf16 v[128:143], a[248:251], v[4:7], v[128:143]
    ds_read_b128 a[240:243], v53 offset:8192
    v_rcp_f16_sdwa v21, v21 dst_sel:WORD_0 dst_unused:UNUSED_PRESERVE src0_sel:WORD_0
    v_pk_fma_f16 v42, v42, s59, s59
    v_exp_f16_sdwa v43, v43 dst_sel:WORD_1 dst_unused:UNUSED_PRESERVE src0_sel:WORD_1
    v_mfma_f32_32x32x16_bf16 v[144:159], a[248:251], v[12:15], v[144:159]
    s_waitcnt lgkmcnt(3)
    buffer_load_dwordx4 v59, s[84:87], s65 offen offset:2048 sc1 lds
    v_mfma_f32_32x32x16_bf16 v[160:175], a[252:255], v[4:7], v[160:175]
    ds_read_b128 a[244:247], v53 offset:9216
    v_exp_f16_sdwa v44, v44 dst_sel:WORD_0 dst_unused:UNUSED_PRESERVE src0_sel:WORD_0
    v_pk_mul_f16 v45, v23, v45
    v_pk_fma_f16 v46, v24, v24, s60
    v_cvt_pk_f16_f32 v22, v254, v255
    v_cvt_pk_bf16_f32 v37, v246, v247
    v_mfma_f32_32x32x16_bf16 v[176:191], a[252:255], v[12:15], v[176:191]
    s_waitcnt lgkmcnt(3)
    v_fma_mix_f32 v232, v232, v20, 0 op_sel:[0,0,0] op_sel_hi:[0,1,0]
    v_fma_mix_f32 v233, v233, v20, 0 op_sel:[0,1,0] op_sel_hi:[0,1,0]
    v_rcp_f16_sdwa v21, v21 dst_sel:WORD_1 dst_unused:UNUSED_PRESERVE src0_sel:WORD_1
    v_rcp_f16_sdwa v42, v42 dst_sel:WORD_0 dst_unused:UNUSED_PRESERVE src0_sel:WORD_0
    v_pk_fma_f16 v43, v43, s59, s59
    v_mfma_f32_32x32x16_bf16 a[0:15], a[232:235], v[8:11], a[0:15]
    s_add_u32 s64, s64, 24576
    ds_read_b128 a[248:251], v53 offset:10240
    v_exp_f16_sdwa v44, v44 dst_sel:WORD_1 dst_unused:UNUSED_PRESERVE src0_sel:WORD_1
    v_exp_f16_sdwa v45, v45 dst_sel:WORD_0 dst_unused:UNUSED_PRESERVE src0_sel:WORD_0
    v_pk_mul_f16 v46, v24, v46
    v_mfma_f32_32x32x16_bf16 a[16:31], a[232:235], v[16:19], a[16:31]
    s_waitcnt lgkmcnt(3)
    v_pk_fma_f16 v47, v22, v22, s60
    v_cvt_pk_bf16_f32 v30, v232, v233
    v_fma_mix_f32 v234, v234, v21, 0 op_sel:[0,0,0] op_sel_hi:[0,1,0]
    v_fma_mix_f32 v235, v235, v21, 0 op_sel:[0,1,0] op_sel_hi:[0,1,0]
    v_rcp_f16_sdwa v42, v42 dst_sel:WORD_1 dst_unused:UNUSED_PRESERVE src0_sel:WORD_1
    v_mfma_f32_32x32x16_bf16 a[32:47], a[236:239], v[8:11], a[32:47]
    s_add_u32 s65, s65, 24576
    ds_read_b128 a[252:255], v53 offset:11264
    v_rcp_f16_sdwa v43, v43 dst_sel:WORD_0 dst_unused:UNUSED_PRESERVE src0_sel:WORD_0
    v_pk_fma_f16 v44, v44, s59, s59
    v_exp_f16_sdwa v45, v45 dst_sel:WORD_1 dst_unused:UNUSED_PRESERVE src0_sel:WORD_1
    v_mfma_f32_32x32x16_bf16 a[48:63], a[236:239], v[16:19], a[48:63]
    s_waitcnt lgkmcnt(3)
    v_exp_f16_sdwa v46, v46 dst_sel:WORD_0 dst_unused:UNUSED_PRESERVE src0_sel:WORD_0
    v_pk_mul_f16 v47, v22, v47
    v_cvt_pk_bf16_f32 v31, v234, v235
    v_fma_mix_f32 v236, v236, v42, 0 op_sel:[0,0,0] op_sel_hi:[0,1,0]
    v_fma_mix_f32 v237, v237, v42, 0 op_sel:[0,1,0] op_sel_hi:[0,1,0]
    v_mfma_f32_32x32x16_bf16 v[64:79], a[240:243], v[8:11], v[64:79]
    s_add_u32 m0, s63, 0
    ds_read_b128 a[232:235], v52 offset:12288
    v_rcp_f16_sdwa v43, v43 dst_sel:WORD_1 dst_unused:UNUSED_PRESERVE src0_sel:WORD_1
    v_rcp_f16_sdwa v44, v44 dst_sel:WORD_0 dst_unused:UNUSED_PRESERVE src0_sel:WORD_0
    v_pk_fma_f16 v45, v45, s59, s59
    v_mfma_f32_32x32x16_bf16 v[80:95], a[240:243], v[16:19], v[80:95]
    s_waitcnt lgkmcnt(3)
    buffer_load_dwordx4 v59, s[84:87], s66 offen offset:0 sc1 lds
    v_mfma_f32_32x32x16_bf16 v[96:111], a[244:247], v[8:11], v[96:111]
    ds_read_b128 a[236:239], v52 offset:13312
    v_exp_f16_sdwa v46, v46 dst_sel:WORD_1 dst_unused:UNUSED_PRESERVE src0_sel:WORD_1
    v_exp_f16_sdwa v47, v47 dst_sel:WORD_0 dst_unused:UNUSED_PRESERVE src0_sel:WORD_0
    v_cvt_pk_bf16_f32 v32, v236, v237
    v_fma_mix_f32 v238, v238, v43, 0 op_sel:[0,0,0] op_sel_hi:[0,1,0]
    v_mfma_f32_32x32x16_bf16 v[112:127], a[244:247], v[16:19], v[112:127]
    s_waitcnt lgkmcnt(3)
    v_fma_mix_f32 v239, v239, v43, 0 op_sel:[0,1,0] op_sel_hi:[0,1,0]
    v_rcp_f16_sdwa v44, v44 dst_sel:WORD_1 dst_unused:UNUSED_PRESERVE src0_sel:WORD_1
    v_rcp_f16_sdwa v45, v45 dst_sel:WORD_0 dst_unused:UNUSED_PRESERVE src0_sel:WORD_0
    v_pk_fma_f16 v46, v46, s59, s59
    v_mfma_f32_32x32x16_bf16 v[128:143], a[248:251], v[8:11], v[128:143]
    ds_read_b128 a[240:243], v52 offset:14336
    v_exp_f16_sdwa v47, v47 dst_sel:WORD_1 dst_unused:UNUSED_PRESERVE src0_sel:WORD_1
    v_cvt_pk_bf16_f32 v33, v238, v239
    v_fma_mix_f32 v248, v248, v44, 0 op_sel:[0,0,0] op_sel_hi:[0,1,0]
    v_fma_mix_f32 v249, v249, v44, 0 op_sel:[0,1,0] op_sel_hi:[0,1,0]
    v_rcp_f16_sdwa v45, v45 dst_sel:WORD_1 dst_unused:UNUSED_PRESERVE src0_sel:WORD_1
    v_mfma_f32_32x32x16_bf16 v[144:159], a[248:251], v[16:19], v[144:159]
    s_waitcnt lgkmcnt(3)
    v_rcp_f16_sdwa v46, v46 dst_sel:WORD_0 dst_unused:UNUSED_PRESERVE src0_sel:WORD_0
    v_pk_fma_f16 v47, v47, s59, s59
    v_cvt_pk_bf16_f32 v38, v248, v249
    v_fma_mix_f32 v250, v250, v45, 0 op_sel:[0,0,0] op_sel_hi:[0,1,0]
    v_fma_mix_f32 v251, v251, v45, 0 op_sel:[0,1,0] op_sel_hi:[0,1,0]
    v_mfma_f32_32x32x16_bf16 v[160:175], a[252:255], v[8:11], v[160:175]
    ds_read_b128 a[244:247], v52 offset:15360
    v_rcp_f16_sdwa v46, v46 dst_sel:WORD_1 dst_unused:UNUSED_PRESERVE src0_sel:WORD_1
    v_rcp_f16_sdwa v47, v47 dst_sel:WORD_0 dst_unused:UNUSED_PRESERVE src0_sel:WORD_0
    v_cvt_pk_bf16_f32 v39, v250, v251
    v_fma_mix_f32 v252, v252, v46, 0 op_sel:[0,0,0] op_sel_hi:[0,1,0]
    v_mfma_f32_32x32x16_bf16 v[176:191], a[252:255], v[16:19], v[176:191]
    s_waitcnt lgkmcnt(3)
    v_fma_mix_f32 v253, v253, v46, 0 op_sel:[0,1,0] op_sel_hi:[0,1,0]
    v_rcp_f16_sdwa v47, v47 dst_sel:WORD_1 dst_unused:UNUSED_PRESERVE src0_sel:WORD_1
    v_cvt_pk_bf16_f32 v40, v252, v253
    v_fma_mix_f32 v254, v254, v47, 0 op_sel:[0,0,0] op_sel_hi:[0,1,0]
    v_fma_mix_f32 v255, v255, v47, 0 op_sel:[0,1,0] op_sel_hi:[0,1,0]
    v_cvt_pk_bf16_f32 v41, v254, v255
    v_mfma_f32_32x32x16_bf16 v[224:239], a[232:235], a[192:195], 0
    ds_read_b128 a[248:251], v52 offset:16384
    v_cvt_pk_f16_f32 v22, v192, v193
    v_pk_fma_f16 v42, v22, v22, s60
    v_cvt_pk_f16_f32 v23, v194, v195
    v_pk_mul_f16 v42, v22, v42
    v_pk_fma_f16 v43, v23, v23, s60
    v_mfma_f32_32x32x16_bf16 v[240:255], a[232:235], a[196:199], 0
    s_waitcnt lgkmcnt(3)
    buffer_load_dwordx4 v59, s[84:87], s66 offen offset:1024 sc1 lds
    v_mfma_f32_32x32x16_bf16 v[224:239], a[236:239], a[200:203], v[224:239]
    ds_read_b128 a[252:255], v52 offset:17408
    v_cvt_pk_f16_f32 v24, v196, v197
    v_exp_f16_sdwa v42, v42 dst_sel:WORD_0 dst_unused:UNUSED_PRESERVE src0_sel:WORD_0
    v_pk_mul_f16 v43, v23, v43
    v_pk_fma_f16 v44, v24, v24, s60
    v_mfma_f32_32x32x16_bf16 v[240:255], a[236:239], a[204:207], v[240:255]
    s_waitcnt lgkmcnt(3)
    v_cvt_pk_f16_f32 v22, v198, v199
    v_exp_f16_sdwa v42, v42 dst_sel:WORD_1 dst_unused:UNUSED_PRESERVE src0_sel:WORD_1
    v_exp_f16_sdwa v43, v43 dst_sel:WORD_0 dst_unused:UNUSED_PRESERVE src0_sel:WORD_0
    v_pk_mul_f16 v44, v24, v44
    v_mfma_f32_32x32x16_bf16 v[224:239], a[240:243], a[208:211], v[224:239]
    ds_read_b128 a[232:235], v52 offset:18432
    v_pk_fma_f16 v45, v22, v22, s60
    v_cvt_pk_f16_f32 v23, v208, v209
    v_pk_fma_f16 v42, v42, s59, s59
    v_exp_f16_sdwa v43, v43 dst_sel:WORD_1 dst_unused:UNUSED_PRESERVE src0_sel:WORD_1
    v_mfma_f32_32x32x16_bf16 v[240:255], a[240:243], a[212:215], v[240:255]
    s_waitcnt lgkmcnt(3)
    v_exp_f16_sdwa v44, v44 dst_sel:WORD_0 dst_unused:UNUSED_PRESERVE src0_sel:WORD_0
    v_pk_mul_f16 v45, v22, v45
    v_pk_fma_f16 v46, v23, v23, s60
    v_cvt_pk_f16_f32 v24, v210, v211
    v_rcp_f16_sdwa v42, v42 dst_sel:WORD_0 dst_unused:UNUSED_PRESERVE src0_sel:WORD_0
    v_mfma_f32_32x32x16_bf16 v[224:239], a[244:247], a[216:219], v[224:239]
    ds_read_b128 a[236:239], v52 offset:19456
    v_pk_fma_f16 v43, v43, s59, s59
    v_exp_f16_sdwa v44, v44 dst_sel:WORD_1 dst_unused:UNUSED_PRESERVE src0_sel:WORD_1
    v_exp_f16_sdwa v45, v45 dst_sel:WORD_0 dst_unused:UNUSED_PRESERVE src0_sel:WORD_0
    v_mfma_f32_32x32x16_bf16 v[240:255], a[244:247], a[220:223], v[240:255]
    s_waitcnt lgkmcnt(3)
    buffer_load_dwordx4 v59, s[84:87], s66 offen offset:2048 sc1 lds
    v_mfma_f32_32x32x16_bf16 v[224:239], a[248:251], a[224:227], v[224:239]
    ds_read_b128 a[240:243], v52 offset:20480
    v_pk_mul_f16 v46, v23, v46
    v_pk_fma_f16 v47, v24, v24, s60
    v_cvt_pk_f16_f32 v22, v212, v213
    v_rcp_f16_sdwa v42, v42 dst_sel:WORD_1 dst_unused:UNUSED_PRESERVE src0_sel:WORD_1
    v_mfma_f32_32x32x16_bf16 v[240:255], a[248:251], a[228:231], v[240:255]
    s_waitcnt lgkmcnt(3)
    v_rcp_f16_sdwa v43, v43 dst_sel:WORD_0 dst_unused:UNUSED_PRESERVE src0_sel:WORD_0
    v_pk_fma_f16 v44, v44, s59, s59
    v_exp_f16_sdwa v45, v45 dst_sel:WORD_1 dst_unused:UNUSED_PRESERVE src0_sel:WORD_1
    v_exp_f16_sdwa v46, v46 dst_sel:WORD_0 dst_unused:UNUSED_PRESERVE src0_sel:WORD_0
    v_mfma_f32_32x32x16_bf16 v[224:239], a[252:255], a[96:99], v[224:239]
    ds_read_b128 a[244:247], v52 offset:21504
    v_pk_mul_f16 v47, v24, v47
    v_pk_fma_f16 v48, v22, v22, s60
    v_cvt_pk_f16_f32 v23, v214, v215
    v_fma_mix_f32 v192, v192, v42, 0 op_sel:[0,0,0] op_sel_hi:[0,1,0]
    v_fma_mix_f32 v193, v193, v42, 0 op_sel:[0,1,0] op_sel_hi:[0,1,0]
    v_mfma_f32_32x32x16_bf16 v[240:255], a[252:255], a[100:103], v[240:255]
    s_waitcnt lgkmcnt(3)
    v_rcp_f16_sdwa v43, v43 dst_sel:WORD_1 dst_unused:UNUSED_PRESERVE src0_sel:WORD_1
    v_rcp_f16_sdwa v44, v44 dst_sel:WORD_0 dst_unused:UNUSED_PRESERVE src0_sel:WORD_0
    v_pk_fma_f16 v45, v45, s59, s59
    v_exp_f16_sdwa v46, v46 dst_sel:WORD_1 dst_unused:UNUSED_PRESERVE src0_sel:WORD_1
    v_mfma_f32_32x32x16_bf16 v[224:239], a[232:235], a[104:107], v[224:239]
    s_add_u32 m0, s63, 3072
    ds_read_b128 a[248:251], v52 offset:22528
    v_exp_f16_sdwa v47, v47 dst_sel:WORD_0 dst_unused:UNUSED_PRESERVE src0_sel:WORD_0
    v_pk_mul_f16 v48, v22, v48
    v_pk_fma_f16 v49, v23, v23, s60
    v_cvt_pk_f16_f32 v24, v200, v201
    v_mfma_f32_32x32x16_bf16 v[240:255], a[232:235], a[108:111], v[240:255]
    s_waitcnt lgkmcnt(3)
    buffer_load_dwordx4 v59, s[84:87], s67 offen offset:0 sc1 lds
    v_mfma_f32_32x32x16_bf16 v[224:239], a[236:239], a[112:115], v[224:239]
    ds_read_b128 a[252:255], v52 offset:23552
    v_cvt_pk_bf16_f32 v4, v192, v193
    v_fma_mix_f32 v194, v194, v43, 0 op_sel:[0,0,0] op_sel_hi:[0,1,0]
    v_fma_mix_f32 v195, v195, v43, 0 op_sel:[0,1,0] op_sel_hi:[0,1,0]
    v_rcp_f16_sdwa v44, v44 dst_sel:WORD_1 dst_unused:UNUSED_PRESERVE src0_sel:WORD_1
    v_mfma_f32_32x32x16_bf16 v[240:255], a[236:239], a[116:119], v[240:255]
    s_waitcnt lgkmcnt(3)
    v_rcp_f16_sdwa v45, v45 dst_sel:WORD_0 dst_unused:UNUSED_PRESERVE src0_sel:WORD_0
    v_pk_fma_f16 v46, v46, s59, s59
    v_exp_f16_sdwa v47, v47 dst_sel:WORD_1 dst_unused:UNUSED_PRESERVE src0_sel:WORD_1
    v_exp_f16_sdwa v48, v48 dst_sel:WORD_0 dst_unused:UNUSED_PRESERVE src0_sel:WORD_0
    v_mfma_f32_32x32x16_bf16 v[224:239], a[240:243], a[120:123], v[224:239]
    ds_read_b128 a[232:235], v53 offset:12288
    v_pk_mul_f16 v49, v23, v49
    v_pk_fma_f16 v20, v24, v24, s60
    v_cvt_pk_f16_f32 v22, v202, v203
    v_cvt_pk_bf16_f32 v5, v194, v195
    v_fma_mix_f32 v196, v196, v44, 0 op_sel:[0,0,0] op_sel_hi:[0,1,0]
    v_mfma_f32_32x32x16_bf16 v[240:255], a[240:243], a[124:127], v[240:255]
    s_waitcnt lgkmcnt(3)
    buffer_load_dwordx4 v59, s[84:87], s67 offen offset:1024 sc1 lds
    v_mfma_f32_32x32x16_bf16 v[224:239], a[244:247], a[160:163], v[224:239]
    ds_read_b128 a[236:239], v53 offset:13312
    v_fma_mix_f32 v197, v197, v44, 0 op_sel:[0,1,0] op_sel_hi:[0,1,0]
    v_rcp_f16_sdwa v45, v45 dst_sel:WORD_1 dst_unused:UNUSED_PRESERVE src0_sel:WORD_1
    v_rcp_f16_sdwa v46, v46 dst_sel:WORD_0 dst_unused:UNUSED_PRESERVE src0_sel:WORD_0
    v_mfma_f32_32x32x16_bf16 v[240:255], a[244:247], a[164:167], v[240:255]
    s_waitcnt lgkmcnt(3)
    v_pk_fma_f16 v47, v47, s59, s59
    v_exp_f16_sdwa v48, v48 dst_sel:WORD_1 dst_unused:UNUSED_PRESERVE src0_sel:WORD_1
    v_exp_f16_sdwa v49, v49 dst_sel:WORD_0 dst_unused:UNUSED_PRESERVE src0_sel:WORD_0
    v_pk_mul_f16 v20, v24, v20
    v_mfma_f32_32x32x16_bf16 v[224:239], a[248:251], a[168:171], v[224:239]
    ds_read_b128 a[240:243], v53 offset:14336
    v_pk_fma_f16 v21, v22, v22, s60
    v_cvt_pk_f16_f32 v23, v204, v205
    v_cvt_pk_bf16_f32 v6, v196, v197
    v_fma_mix_f32 v198, v198, v45, 0 op_sel:[0,0,0] op_sel_hi:[0,1,0]
    v_fma_mix_f32 v199, v199, v45, 0 op_sel:[0,1,0] op_sel_hi:[0,1,0]
    v_mfma_f32_32x32x16_bf16 v[240:255], a[248:251], a[172:175], v[240:255]
    s_waitcnt lgkmcnt(3)
    buffer_load_dwordx4 v59, s[84:87], s67 offen offset:2048 sc1 lds
    v_mfma_f32_32x32x16_bf16 v[224:239], a[252:255], a[176:179], v[224:239]
    ds_read_b128 a[244:247], v53 offset:15360
    v_rcp_f16_sdwa v46, v46 dst_sel:WORD_1 dst_unused:UNUSED_PRESERVE src0_sel:WORD_1
    v_rcp_f16_sdwa v47, v47 dst_sel:WORD_0 dst_unused:UNUSED_PRESERVE src0_sel:WORD_0
    v_pk_fma_f16 v48, v48, s59, s59
    v_mfma_f32_32x32x16_bf16 v[240:255], a[252:255], a[180:183], v[240:255]
    s_waitcnt lgkmcnt(3)
    v_add_u32 v52, s62, v52
    v_exp_f16_sdwa v49, v49 dst_sel:WORD_1 dst_unused:UNUSED_PRESERVE src0_sel:WORD_1
    v_exp_f16_sdwa v20, v20 dst_sel:WORD_0 dst_unused:UNUSED_PRESERVE src0_sel:WORD_0
    v_pk_mul_f16 v21, v22, v21
    v_mfma_f32_32x32x16_bf16 a[0:15], a[232:235], v[26:29], a[0:15]
    s_add_u32 s66, s66, 24576
    ds_read_b128 a[248:251], v53 offset:16384
    v_pk_fma_f16 v42, v23, v23, s60
    v_cvt_pk_f16_f32 v24, v206, v207
    v_cvt_pk_bf16_f32 v7, v198, v199
    v_fma_mix_f32 v208, v208, v46, 0 op_sel:[0,0,0] op_sel_hi:[0,1,0]
    v_fma_mix_f32 v209, v209, v46, 0 op_sel:[0,1,0] op_sel_hi:[0,1,0]
    v_mfma_f32_32x32x16_bf16 a[16:31], a[232:235], v[34:37], a[16:31]
    s_waitcnt lgkmcnt(3)
    v_rcp_f16_sdwa v47, v47 dst_sel:WORD_1 dst_unused:UNUSED_PRESERVE src0_sel:WORD_1
    v_rcp_f16_sdwa v48, v48 dst_sel:WORD_0 dst_unused:UNUSED_PRESERVE src0_sel:WORD_0
    v_pk_fma_f16 v49, v49, s59, s59
    v_exp_f16_sdwa v20, v20 dst_sel:WORD_1 dst_unused:UNUSED_PRESERVE src0_sel:WORD_1
    v_mfma_f32_32x32x16_bf16 a[32:47], a[236:239], v[26:29], a[32:47]
    s_add_u32 s67, s67, 24576
    ds_read_b128 a[252:255], v53 offset:17408
    v_exp_f16_sdwa v21, v21 dst_sel:WORD_0 dst_unused:UNUSED_PRESERVE src0_sel:WORD_0
    v_pk_mul_f16 v42, v23, v42
    v_pk_fma_f16 v43, v24, v24, s60
    v_cvt_pk_f16_f32 v22, v216, v217
    v_mfma_f32_32x32x16_bf16 a[48:63], a[236:239], v[34:37], a[48:63]
    s_waitcnt lgkmcnt(3)
    v_cvt_pk_bf16_f32 v12, v208, v209
    v_fma_mix_f32 v210, v210, v47, 0 op_sel:[0,0,0] op_sel_hi:[0,1,0]
    v_fma_mix_f32 v211, v211, v47, 0 op_sel:[0,1,0] op_sel_hi:[0,1,0]
    v_rcp_f16_sdwa v48, v48 dst_sel:WORD_1 dst_unused:UNUSED_PRESERVE src0_sel:WORD_1
    v_rcp_f16_sdwa v49, v49 dst_sel:WORD_0 dst_unused:UNUSED_PRESERVE src0_sel:WORD_0
    v_mfma_f32_32x32x16_bf16 v[64:79], a[240:243], v[26:29], v[64:79]
    s_sub_u32 s63, s63, s62
    ds_read_b128 a[232:235], v53 offset:18432
    v_pk_fma_f16 v20, v20, s59, s59
    v_exp_f16_sdwa v21, v21 dst_sel:WORD_1 dst_unused:UNUSED_PRESERVE src0_sel:WORD_1
    v_exp_f16_sdwa v42, v42 dst_sel:WORD_0 dst_unused:UNUSED_PRESERVE src0_sel:WORD_0
    v_mfma_f32_32x32x16_bf16 v[80:95], a[240:243], v[34:37], v[80:95]
    s_waitcnt lgkmcnt(3)
    v_pk_mul_f16 v43, v24, v43
    v_pk_fma_f16 v44, v22, v22, s60
    v_cvt_pk_f16_f32 v23, v218, v219
    v_cvt_pk_bf16_f32 v13, v210, v211
    v_fma_mix_f32 v212, v212, v48, 0 op_sel:[0,0,0] op_sel_hi:[0,1,0]
    v_fma_mix_f32 v213, v213, v48, 0 op_sel:[0,1,0] op_sel_hi:[0,1,0]
    v_mfma_f32_32x32x16_bf16 v[96:111], a[244:247], v[26:29], v[96:111]
    ds_read_b128 a[236:239], v53 offset:19456
    v_rcp_f16_sdwa v49, v49 dst_sel:WORD_1 dst_unused:UNUSED_PRESERVE src0_sel:WORD_1
    v_rcp_f16_sdwa v20, v20 dst_sel:WORD_0 dst_unused:UNUSED_PRESERVE src0_sel:WORD_0
    v_pk_fma_f16 v21, v21, s59, s59
    v_mfma_f32_32x32x16_bf16 v[112:127], a[244:247], v[34:37], v[112:127]
    s_waitcnt lgkmcnt(3)
    v_exp_f16_sdwa v42, v42 dst_sel:WORD_1 dst_unused:UNUSED_PRESERVE src0_sel:WORD_1
    v_exp_f16_sdwa v43, v43 dst_sel:WORD_0 dst_unused:UNUSED_PRESERVE src0_sel:WORD_0
    v_pk_mul_f16 v44, v22, v44
    v_pk_fma_f16 v45, v23, v23, s60
    v_mfma_f32_32x32x16_bf16 v[128:143], a[248:251], v[26:29], v[128:143]
    ds_read_b128 a[240:243], v53 offset:20480
    v_cvt_pk_f16_f32 v24, v220, v221
    v_cvt_pk_bf16_f32 v14, v212, v213
    v_fma_mix_f32 v214, v214, v49, 0 op_sel:[0,0,0] op_sel_hi:[0,1,0]
    v_fma_mix_f32 v215, v215, v49, 0 op_sel:[0,1,0] op_sel_hi:[0,1,0]
    v_rcp_f16_sdwa v20, v20 dst_sel:WORD_1 dst_unused:UNUSED_PRESERVE src0_sel:WORD_1
    v_mfma_f32_32x32x16_bf16 v[144:159], a[248:251], v[34:37], v[144:159]
    s_waitcnt lgkmcnt(3)
    v_rcp_f16_sdwa v21, v21 dst_sel:WORD_0 dst_unused:UNUSED_PRESERVE src0_sel:WORD_0
    v_pk_fma_f16 v42, v42, s59, s59
    v_exp_f16_sdwa v43, v43 dst_sel:WORD_1 dst_unused:UNUSED_PRESERVE src0_sel:WORD_1
    v_exp_f16_sdwa v44, v44 dst_sel:WORD_0 dst_unused:UNUSED_PRESERVE src0_sel:WORD_0
    v_mfma_f32_32x32x16_bf16 v[160:175], a[252:255], v[26:29], v[160:175]
    ds_read_b128 a[244:247], v53 offset:21504
    v_pk_mul_f16 v45, v23, v45
    v_pk_fma_f16 v46, v24, v24, s60
    v_cvt_pk_f16_f32 v22, v222, v223
    v_cvt_pk_bf16_f32 v15, v214, v215
    v_fma_mix_f32 v200, v200, v20, 0 op_sel:[0,0,0] op_sel_hi:[0,1,0]
    v_mfma_f32_32x32x16_bf16 v[176:191], a[252:255], v[34:37], v[176:191]
    s_waitcnt lgkmcnt(3)
    v_fma_mix_f32 v201, v201, v20, 0 op_sel:[0,1,0] op_sel_hi:[0,1,0]
    v_rcp_f16_sdwa v21, v21 dst_sel:WORD_1 dst_unused:UNUSED_PRESERVE src0_sel:WORD_1
    v_rcp_f16_sdwa v42, v42 dst_sel:WORD_0 dst_unused:UNUSED_PRESERVE src0_sel:WORD_0
    v_pk_fma_f16 v43, v43, s59, s59
    v_mfma_f32_32x32x16_bf16 a[0:15], a[232:235], v[30:33], a[0:15]
    ds_read_b128 a[248:251], v53 offset:22528
    v_exp_f16_sdwa v44, v44 dst_sel:WORD_1 dst_unused:UNUSED_PRESERVE src0_sel:WORD_1
    v_exp_f16_sdwa v45, v45 dst_sel:WORD_0 dst_unused:UNUSED_PRESERVE src0_sel:WORD_0
    v_pk_mul_f16 v46, v24, v46
    v_mfma_f32_32x32x16_bf16 a[16:31], a[232:235], v[38:41], a[16:31]
    s_waitcnt lgkmcnt(3)
    v_pk_fma_f16 v47, v22, v22, s60
    v_cvt_pk_bf16_f32 v8, v200, v201
    v_fma_mix_f32 v202, v202, v21, 0 op_sel:[0,0,0] op_sel_hi:[0,1,0]
    v_fma_mix_f32 v203, v203, v21, 0 op_sel:[0,1,0] op_sel_hi:[0,1,0]
    v_rcp_f16_sdwa v42, v42 dst_sel:WORD_1 dst_unused:UNUSED_PRESERVE src0_sel:WORD_1
    v_mfma_f32_32x32x16_bf16 a[32:47], a[236:239], v[30:33], a[32:47]
    ds_read_b128 a[252:255], v53 offset:23552
    v_rcp_f16_sdwa v43, v43 dst_sel:WORD_0 dst_unused:UNUSED_PRESERVE src0_sel:WORD_0
    v_pk_fma_f16 v44, v44, s59, s59
    v_exp_f16_sdwa v45, v45 dst_sel:WORD_1 dst_unused:UNUSED_PRESERVE src0_sel:WORD_1
    v_mfma_f32_32x32x16_bf16 a[48:63], a[236:239], v[38:41], a[48:63]
    s_waitcnt lgkmcnt(3)
    v_add_u32 v53, s62, v53
    v_exp_f16_sdwa v46, v46 dst_sel:WORD_0 dst_unused:UNUSED_PRESERVE src0_sel:WORD_0
    v_pk_mul_f16 v47, v22, v47
    v_cvt_pk_bf16_f32 v9, v202, v203
    v_fma_mix_f32 v204, v204, v42, 0 op_sel:[0,0,0] op_sel_hi:[0,1,0]
    v_mfma_f32_32x32x16_bf16 v[64:79], a[240:243], v[30:33], v[64:79]
    s_waitcnt vmcnt(0)
    s_barrier
    ds_read_b128 a[232:235], v52 offset:0
    v_fma_mix_f32 v205, v205, v42, 0 op_sel:[0,1,0] op_sel_hi:[0,1,0]
    v_rcp_f16_sdwa v43, v43 dst_sel:WORD_1 dst_unused:UNUSED_PRESERVE src0_sel:WORD_1
    v_mfma_f32_32x32x16_bf16 v[80:95], a[240:243], v[38:41], v[80:95]
    s_waitcnt lgkmcnt(3)
    v_rcp_f16_sdwa v44, v44 dst_sel:WORD_0 dst_unused:UNUSED_PRESERVE src0_sel:WORD_0
    v_pk_fma_f16 v45, v45, s59, s59
    v_exp_f16_sdwa v46, v46 dst_sel:WORD_1 dst_unused:UNUSED_PRESERVE src0_sel:WORD_1
    v_exp_f16_sdwa v47, v47 dst_sel:WORD_0 dst_unused:UNUSED_PRESERVE src0_sel:WORD_0
    v_mfma_f32_32x32x16_bf16 v[96:111], a[244:247], v[30:33], v[96:111]
    s_sub_u32 s62, 0, s62
    ds_read_b128 a[236:239], v52 offset:1024
    v_cvt_pk_bf16_f32 v10, v204, v205
    v_fma_mix_f32 v206, v206, v43, 0 op_sel:[0,0,0] op_sel_hi:[0,1,0]
    v_fma_mix_f32 v207, v207, v43, 0 op_sel:[0,1,0] op_sel_hi:[0,1,0]
    v_rcp_f16_sdwa v44, v44 dst_sel:WORD_1 dst_unused:UNUSED_PRESERVE src0_sel:WORD_1
    v_mfma_f32_32x32x16_bf16 v[112:127], a[244:247], v[38:41], v[112:127]
    s_waitcnt lgkmcnt(3)
    v_rcp_f16_sdwa v45, v45 dst_sel:WORD_0 dst_unused:UNUSED_PRESERVE src0_sel:WORD_0
    v_pk_fma_f16 v46, v46, s59, s59
    v_exp_f16_sdwa v47, v47 dst_sel:WORD_1 dst_unused:UNUSED_PRESERVE src0_sel:WORD_1
    v_cvt_pk_bf16_f32 v11, v206, v207
    v_fma_mix_f32 v216, v216, v44, 0 op_sel:[0,0,0] op_sel_hi:[0,1,0]
    v_mfma_f32_32x32x16_bf16 v[128:143], a[248:251], v[30:33], v[128:143]
    s_sub_u32 s68, s68, 1
    ds_read_b128 a[240:243], v52 offset:2048
    v_fma_mix_f32 v217, v217, v44, 0 op_sel:[0,1,0] op_sel_hi:[0,1,0]
    v_rcp_f16_sdwa v45, v45 dst_sel:WORD_1 dst_unused:UNUSED_PRESERVE src0_sel:WORD_1
    v_rcp_f16_sdwa v46, v46 dst_sel:WORD_0 dst_unused:UNUSED_PRESERVE src0_sel:WORD_0
    v_pk_fma_f16 v47, v47, s59, s59
    v_mfma_f32_32x32x16_bf16 v[144:159], a[248:251], v[38:41], v[144:159]
    s_waitcnt lgkmcnt(3)
    v_cvt_pk_bf16_f32 v16, v216, v217
    v_fma_mix_f32 v218, v218, v45, 0 op_sel:[0,0,0] op_sel_hi:[0,1,0]
    v_fma_mix_f32 v219, v219, v45, 0 op_sel:[0,1,0] op_sel_hi:[0,1,0]
    v_rcp_f16_sdwa v46, v46 dst_sel:WORD_1 dst_unused:UNUSED_PRESERVE src0_sel:WORD_1
    v_rcp_f16_sdwa v47, v47 dst_sel:WORD_0 dst_unused:UNUSED_PRESERVE src0_sel:WORD_0
    v_mfma_f32_32x32x16_bf16 v[160:175], a[252:255], v[30:33], v[160:175]
    s_cmp_lg_u32 s68, 0
    ds_read_b128 a[244:247], v52 offset:3072
    v_cvt_pk_bf16_f32 v17, v218, v219
    v_fma_mix_f32 v220, v220, v46, 0 op_sel:[0,0,0] op_sel_hi:[0,1,0]
    v_fma_mix_f32 v221, v221, v46, 0 op_sel:[0,1,0] op_sel_hi:[0,1,0]
    v_rcp_f16_sdwa v47, v47 dst_sel:WORD_1 dst_unused:UNUSED_PRESERVE src0_sel:WORD_1
    v_mfma_f32_32x32x16_bf16 v[176:191], a[252:255], v[38:41], v[176:191]
    s_waitcnt lgkmcnt(3)
    v_cvt_pk_bf16_f32 v18, v220, v221
    v_fma_mix_f32 v222, v222, v47, 0 op_sel:[0,0,0] op_sel_hi:[0,1,0]
    v_fma_mix_f32 v223, v223, v47, 0 op_sel:[0,1,0] op_sel_hi:[0,1,0]
    v_cvt_pk_bf16_f32 v19, v222, v223
    s_cbranch_scc1 L_loop
L_tail:
    ds_read_b128 a[192:195], v53 offset:0
    ds_read_b128 a[196:199], v53 offset:6144
    ds_read_b128 a[200:203], v53 offset:1024
    ds_read_b128 a[204:207], v53 offset:7168
    ds_read_b128 a[208:211], v53 offset:2048
    ds_read_b128 a[212:215], v53 offset:8192
    v_xor_b32 v56, 32, v25
    v_xor_b32 v57, 64, v25
    v_xor_b32 v58, 96, v25
    s_mov_b32 s44, 0
    s_mov_b32 s45, 688128
    s_mov_b32 s46, 384
    s_mov_b32 s47, 688512
    s_mov_b32 s48, 86016
    s_mov_b32 s49, 774144
    s_mov_b32 s50, 86400
    s_mov_b32 s51, 774528
    v_cvt_pk_f16_f32 v22, v224, v225
    v_pk_fma_f16 v42, v22, v22, s60
    v_cvt_pk_f16_f32 v23, v226, v227
    v_pk_mul_f16 v42, v22, v42
    v_pk_fma_f16 v43, v23, v23, s60
    v_cvt_pk_f16_f32 v24, v228, v229
    v_exp_f16_sdwa v42, v42 dst_sel:WORD_0 dst_unused:UNUSED_PRESERVE src0_sel:WORD_0
    v_pk_mul_f16 v43, v23, v43
    v_pk_fma_f16 v44, v24, v24, s60
    v_cvt_pk_f16_f32 v22, v230, v231
    v_exp_f16_sdwa v42, v42 dst_sel:WORD_1 dst_unused:UNUSED_PRESERVE src0_sel:WORD_1
    v_exp_f16_sdwa v43, v43 dst_sel:WORD_0 dst_unused:UNUSED_PRESERVE src0_sel:WORD_0
    s_waitcnt lgkmcnt(5)
    v_mfma_f32_32x32x16_bf16 a[0:15], a[192:195], v[4:7], a[0:15]
    s_waitcnt lgkmcnt(4)
    ds_read_b128 a[216:219], v53 offset:3072
    ds_read_b128 a[220:223], v53 offset:9216
    v_pk_mul_f16 v44, v24, v44
    v_pk_fma_f16 v45, v22, v22, s60
    v_cvt_pk_f16_f32 v23, v232, v233
    v_pk_fma_f16 v42, v42, s59, s59
    v_exp_f16_sdwa v43, v43 dst_sel:WORD_1 dst_unused:UNUSED_PRESERVE src0_sel:WORD_1
    v_mfma_f32_32x32x16_bf16 a[0:15], a[196:199], v[8:11], a[0:15]
    s_waitcnt lgkmcnt(5)
    ds_read_b128 a[224:227], v53 offset:4096
    ds_read_b128 a[228:231], v53 offset:10240
    v_exp_f16_sdwa v44, v44 dst_sel:WORD_0 dst_unused:UNUSED_PRESERVE src0_sel:WORD_0
    v_pk_mul_f16 v45, v22, v45
    v_pk_fma_f16 v46, v23, v23, s60
    v_cvt_pk_f16_f32 v24, v234, v235
    v_rcp_f16_sdwa v42, v42 dst_sel:WORD_0 dst_unused:UNUSED_PRESERVE src0_sel:WORD_0
    v_mfma_f32_32x32x16_bf16 a[32:47], a[200:203], v[4:7], a[32:47]
    s_waitcnt lgkmcnt(6)
    ds_read_b128 a[96:99], v53 offset:5120
    ds_read_b128 a[100:103], v53 offset:11264
    v_pk_fma_f16 v43, v43, s59, s59
    v_exp_f16_sdwa v44, v44 dst_sel:WORD_1 dst_unused:UNUSED_PRESERVE src0_sel:WORD_1
    v_exp_f16_sdwa v45, v45 dst_sel:WORD_0 dst_unused:UNUSED_PRESERVE src0_sel:WORD_0
    v_pk_mul_f16 v46, v23, v46
    v_mfma_f32_32x32x16_bf16 a[32:47], a[204:207], v[8:11], a[32:47]
    s_waitcnt lgkmcnt(7)
    ds_read_b128 a[104:107], v53 offset:12288
    ds_read_b128 a[108:111], v53 offset:18432
    v_pk_fma_f16 v47, v24, v24, s60
    v_cvt_pk_f16_f32 v22, v236, v237
    v_rcp_f16_sdwa v42, v42 dst_sel:WORD_1 dst_unused:UNUSED_PRESERVE src0_sel:WORD_1
    v_rcp_f16_sdwa v43, v43 dst_sel:WORD_0 dst_unused:UNUSED_PRESERVE src0_sel:WORD_0
    v_mfma_f32_32x32x16_bf16 v[64:79], a[208:211], v[4:7], v[64:79]
    s_waitcnt lgkmcnt(8)
    ds_read_b128 a[112:115], v53 offset:13312
    ds_read_b128 a[116:119], v53 offset:19456
    v_pk_fma_f16 v44, v44, s59, s59
    v_exp_f16_sdwa v45, v45 dst_sel:WORD_1 dst_unused:UNUSED_PRESERVE src0_sel:WORD_1
    v_exp_f16_sdwa v46, v46 dst_sel:WORD_0 dst_unused:UNUSED_PRESERVE src0_sel:WORD_0
    v_pk_mul_f16 v47, v24, v47
    v_mfma_f32_32x32x16_bf16 v[64:79], a[212:215], v[8:11], v[64:79]
    s_waitcnt lgkmcnt(9)
    ds_read_b128 a[120:123], v53 offset:14336
    ds_read_b128 a[124:127], v53 offset:20480
    v_pk_fma_f16 v48, v22, v22, s60
    v_cvt_pk_f16_f32 v23, v238, v239
    v_fma_mix_f32 v224, v224, v42, 0 op_sel:[0,0,0] op_sel_hi:[0,1,0]
    v_fma_mix_f32 v225, v225, v42, 0 op_sel:[0,1,0] op_sel_hi:[0,1,0]
    v_rcp_f16_sdwa v43, v43 dst_sel:WORD_1 dst_unused:UNUSED_PRESERVE src0_sel:WORD_1
    v_mfma_f32_32x32x16_bf16 v[96:111], a[216:219], v[4:7], v[96:111]
    s_waitcnt lgkmcnt(10)
    ds_read_b128 a[160:163], v53 offset:15360
    ds_read_b128 a[164:167], v53 offset:21504
    v_rcp_f16_sdwa v44, v44 dst_sel:WORD_0 dst_unused:UNUSED_PRESERVE src0_sel:WORD_0
    v_pk_fma_f16 v45, v45, s59, s59
    v_exp_f16_sdwa v46, v46 dst_sel:WORD_1 dst_unused:UNUSED_PRESERVE src0_sel:WORD_1
    v_exp_f16_sdwa v47, v47 dst_sel:WORD_0 dst_unused:UNUSED_PRESERVE src0_sel:WORD_0
    v_mfma_f32_32x32x16_bf16 v[96:111], a[220:223], v[8:11], v[96:111]
    s_waitcnt lgkmcnt(11)
    ds_read_b128 a[168:171], v53 offset:16384
    ds_read_b128 a[172:175], v53 offset:22528
    v_pk_mul_f16 v48, v22, v48
    v_pk_fma_f16 v49, v23, v23, s60
    v_cvt_pk_bf16_f32 v26, v224, v225
    v_fma_mix_f32 v226, v226, v43, 0 op_sel:[0,0,0] op_sel_hi:[0,1,0]
    v_fma_mix_f32 v227, v227, v43, 0 op_sel:[0,1,0] op_sel_hi:[0,1,0]
    v_rcp_f16_sdwa v44, v44 dst_sel:WORD_1 dst_unused:UNUSED_PRESERVE src0_sel:WORD_1
    v_mfma_f32_32x32x16_bf16 v[128:143], a[224:227], v[4:7], v[128:143]
    s_waitcnt lgkmcnt(12)
    ds_read_b128 a[176:179], v53 offset:17408
    ds_read_b128 a[180:183], v53 offset:23552
    v_rcp_f16_sdwa v45, v45 dst_sel:WORD_0 dst_unused:UNUSED_PRESERVE src0_sel:WORD_0
    v_pk_fma_f16 v46, v46, s59, s59
    v_exp_f16_sdwa v47, v47 dst_sel:WORD_1 dst_unused:UNUSED_PRESERVE src0_sel:WORD_1
    v_exp_f16_sdwa v48, v48 dst_sel:WORD_0 dst_unused:UNUSED_PRESERVE src0_sel:WORD_0
    v_mfma_f32_32x32x16_bf16 v[128:143], a[228:231], v[8:11], v[128:143]
    s_waitcnt lgkmcnt(13)
    v_pk_mul_f16 v49, v23, v49
    v_cvt_pk_bf16_f32 v27, v226, v227
    v_fma_mix_f32 v228, v228, v44, 0 op_sel:[0,0,0] op_sel_hi:[0,1,0]
    v_fma_mix_f32 v229, v229, v44, 0 op_sel:[0,1,0] op_sel_hi:[0,1,0]
    v_rcp_f16_sdwa v45, v45 dst_sel:WORD_1 dst_unused:UNUSED_PRESERVE src0_sel:WORD_1
    v_mfma_f32_32x32x16_bf16 v[160:175], a[96:99], v[4:7], v[160:175]
    s_waitcnt lgkmcnt(12)
    v_rcp_f16_sdwa v46, v46 dst_sel:WORD_0 dst_unused:UNUSED_PRESERVE src0_sel:WORD_0
    v_pk_fma_f16 v47, v47, s59, s59
    v_exp_f16_sdwa v48, v48 dst_sel:WORD_1 dst_unused:UNUSED_PRESERVE src0_sel:WORD_1
    v_exp_f16_sdwa v49, v49 dst_sel:WORD_0 dst_unused:UNUSED_PRESERVE src0_sel:WORD_0
    v_mfma_f32_32x32x16_bf16 v[160:175], a[100:103], v[8:11], v[160:175]
    s_waitcnt lgkmcnt(11)
    v_cvt_pk_bf16_f32 v28, v228, v229
    v_fma_mix_f32 v230, v230, v45, 0 op_sel:[0,0,0] op_sel_hi:[0,1,0]
    v_fma_mix_f32 v231, v231, v45, 0 op_sel:[0,1,0] op_sel_hi:[0,1,0]
    v_rcp_f16_sdwa v46, v46 dst_sel:WORD_1 dst_unused:UNUSED_PRESERVE src0_sel:WORD_1
    v_rcp_f16_sdwa v47, v47 dst_sel:WORD_0 dst_unused:UNUSED_PRESERVE src0_sel:WORD_0
    v_pk_fma_f16 v48, v48, s59, s59
    v_exp_f16_sdwa v49, v49 dst_sel:WORD_1 dst_unused:UNUSED_PRESERVE src0_sel:WORD_1
    v_cvt_pk_bf16_f32 v29, v230, v231
    v_fma_mix_f32 v232, v232, v46, 0 op_sel:[0,0,0] op_sel_hi:[0,1,0]
    v_fma_mix_f32 v233, v233, v46, 0 op_sel:[0,1,0] op_sel_hi:[0,1,0]
    v_rcp_f16_sdwa v47, v47 dst_sel:WORD_1 dst_unused:UNUSED_PRESERVE src0_sel:WORD_1
    v_rcp_f16_sdwa v48, v48 dst_sel:WORD_0 dst_unused:UNUSED_PRESERVE src0_sel:WORD_0
    v_pk_fma_f16 v49, v49, s59, s59
    v_cvt_pk_bf16_f32 v30, v232, v233
    v_fma_mix_f32 v234, v234, v47, 0 op_sel:[0,0,0] op_sel_hi:[0,1,0]
    v_fma_mix_f32 v235, v235, v47, 0 op_sel:[0,1,0] op_sel_hi:[0,1,0]
    v_rcp_f16_sdwa v48, v48 dst_sel:WORD_1 dst_unused:UNUSED_PRESERVE src0_sel:WORD_1
    v_rcp_f16_sdwa v49, v49 dst_sel:WORD_0 dst_unused:UNUSED_PRESERVE src0_sel:WORD_0
    v_cvt_pk_bf16_f32 v31, v234, v235
    v_fma_mix_f32 v236, v236, v48, 0 op_sel:[0,0,0] op_sel_hi:[0,1,0]
    v_fma_mix_f32 v237, v237, v48, 0 op_sel:[0,1,0] op_sel_hi:[0,1,0]
    v_rcp_f16_sdwa v49, v49 dst_sel:WORD_1 dst_unused:UNUSED_PRESERVE src0_sel:WORD_1
    v_cvt_pk_bf16_f32 v32, v236, v237
    v_fma_mix_f32 v238, v238, v49, 0 op_sel:[0,0,0] op_sel_hi:[0,1,0]
    v_fma_mix_f32 v239, v239, v49, 0 op_sel:[0,1,0] op_sel_hi:[0,1,0]
    v_cvt_pk_bf16_f32 v33, v238, v239
    v_cvt_pk_f16_f32 v22, v240, v241
    v_pk_fma_f16 v42, v22, v22, s60
    v_mfma_f32_32x32x16_bf16 a[0:15], a[104:107], v[26:29], a[0:15]
    s_waitcnt lgkmcnt(10)
    v_cvt_pk_f16_f32 v23, v242, v243
    v_pk_mul_f16 v42, v22, v42
    v_pk_fma_f16 v43, v23, v23, s60
    v_cvt_pk_f16_f32 v24, v244, v245
    v_exp_f16_sdwa v42, v42 dst_sel:WORD_0 dst_unused:UNUSED_PRESERVE src0_sel:WORD_0
    v_mfma_f32_32x32x16_bf16 a[0:15], a[108:111], v[30:33], a[0:15]
    s_waitcnt lgkmcnt(9)
    v_pk_mul_f16 v43, v23, v43
    v_pk_fma_f16 v44, v24, v24, s60
    v_cvt_pk_f16_f32 v22, v246, v247
    v_exp_f16_sdwa v42, v42 dst_sel:WORD_1 dst_unused:UNUSED_PRESERVE src0_sel:WORD_1
    v_exp_f16_sdwa v43, v43 dst_sel:WORD_0 dst_unused:UNUSED_PRESERVE src0_sel:WORD_0
    v_mfma_f32_32x32x16_bf16 a[32:47], a[112:115], v[26:29], a[32:47]
    s_waitcnt lgkmcnt(8)
    v_pk_mul_f16 v44, v24, v44
    v_pk_fma_f16 v45, v22, v22, s60
    v_cvt_pk_f16_f32 v23, v248, v249
    v_pk_fma_f16 v42, v42, s59, s59
    v_exp_f16_sdwa v43, v43 dst_sel:WORD_1 dst_unused:UNUSED_PRESERVE src0_sel:WORD_1
    v_mfma_f32_32x32x16_bf16 a[32:47], a[116:119], v[30:33], a[32:47]
    s_waitcnt lgkmcnt(7)
    v_exp_f16_sdwa v44, v44 dst_sel:WORD_0 dst_unused:UNUSED_PRESERVE src0_sel:WORD_0
    v_pk_mul_f16 v45, v22, v45
    v_pk_fma_f16 v46, v23, v23, s60
    v_cvt_pk_f16_f32 v24, v250, v251
    v_rcp_f16_sdwa v42, v42 dst_sel:WORD_0 dst_unused:UNUSED_PRESERVE src0_sel:WORD_0
    v_mfma_f32_32x32x16_bf16 v[64:79], a[120:123], v[26:29], v[64:79]
    s_waitcnt lgkmcnt(6)
    v_pk_fma_f16 v43, v43, s59, s59
    v_exp_f16_sdwa v44, v44 dst_sel:WORD_1 dst_unused:UNUSED_PRESERVE src0_sel:WORD_1
    v_accvgpr_read_b32 v192, a0
    v_accvgpr_read_b32 v193, a1
    v_accvgpr_read_b32 v194, a2
    v_mfma_f32_32x32x16_bf16 v[64:79], a[124:127], v[30:33], v[64:79]
    s_waitcnt lgkmcnt(5)
    v_accvgpr_read_b32 v195, a3
    v_accvgpr_read_b32 v196, a4
    v_accvgpr_read_b32 v197, a5
    v_accvgpr_read_b32 v198, a6
    v_accvgpr_read_b32 v199, a7
    v_accvgpr_read_b32 v200, a8
    v_mfma_f32_32x32x16_bf16 v[96:111], a[160:163], v[26:29], v[96:111]
    s_waitcnt lgkmcnt(4)
    v_accvgpr_read_b32 v201, a9
    v_accvgpr_read_b32 v202, a10
    v_accvgpr_read_b32 v203, a11
    v_accvgpr_read_b32 v204, a12
    v_accvgpr_read_b32 v205, a13
    v_accvgpr_read_b32 v206, a14
    v_mfma_f32_32x32x16_bf16 v[96:111], a[164:167], v[30:33], v[96:111]
    s_waitcnt lgkmcnt(3)
    v_accvgpr_read_b32 v207, a15
    v_cvt_pk_bf16_f32 v208, v192, v193
    v_cvt_pk_bf16_f32 v209, v194, v195
    v_cvt_pk_bf16_f32 v210, v196, v197
    v_cvt_pk_bf16_f32 v211, v198, v199
    v_cvt_pk_bf16_f32 v212, v200, v201
    v_mfma_f32_32x32x16_bf16 v[128:143], a[168:171], v[26:29], v[128:143]
    s_waitcnt lgkmcnt(2)
    v_cvt_pk_bf16_f32 v213, v202, v203
    v_cvt_pk_bf16_f32 v214, v204, v205
    v_cvt_pk_bf16_f32 v215, v206, v207
    ds_write_b128 v25, v[208:211] offset:0
    v_mfma_f32_32x32x16_bf16 v[128:143], a[172:175], v[30:33], v[128:143]
    s_waitcnt lgkmcnt(2)
    ds_write_b128 v56, v[212:215] offset:0
    v_accvgpr_read_b32 v192, a32
    v_mfma_f32_32x32x16_bf16 v[160:175], a[176:179], v[26:29], v[160:175]
    s_waitcnt lgkmcnt(2)
    v_accvgpr_read_b32 v193, a33
    v_accvgpr_read_b32 v194, a34
    v_accvgpr_read_b32 v195, a35
    v_accvgpr_read_b32 v196, a36
    v_accvgpr_read_b32 v197, a37
    v_accvgpr_read_b32 v198, a38
    v_mfma_f32_32x32x16_bf16 v[160:175], a[180:183], v[30:33], v[160:175]
    v_accvgpr_read_b32 v199, a39
    v_accvgpr_read_b32 v200, a40
    v_accvgpr_read_b32 v201, a41
    v_accvgpr_read_b32 v202, a42
    v_accvgpr_read_b32 v203, a43
    v_accvgpr_read_b32 v204, a44
    v_mfma_f32_32x32x16_bf16 a[16:31], a[192:195], v[12:15], a[16:31]
    v_accvgpr_read_b32 v205, a45
    v_accvgpr_read_b32 v206, a46
    v_accvgpr_read_b32 v207, a47
    v_cvt_pk_bf16_f32 v216, v192, v193
    v_cvt_pk_bf16_f32 v217, v194, v195
    v_cvt_pk_bf16_f32 v218, v196, v197
    v_mfma_f32_32x32x16_bf16 a[16:31], a[196:199], v[16:19], a[16:31]
    v_cvt_pk_bf16_f32 v219, v198, v199
    v_cvt_pk_bf16_f32 v220, v200, v201
    v_cvt_pk_bf16_f32 v221, v202, v203
    v_cvt_pk_bf16_f32 v222, v204, v205
    v_cvt_pk_bf16_f32 v223, v206, v207
    ds_write_b128 v57, v[216:219] offset:0
    v_mfma_f32_32x32x16_bf16 a[48:63], a[200:203], v[12:15], a[48:63]
    ds_write_b128 v58, v[220:223] offset:0
    v_mfma_f32_32x32x16_bf16 a[48:63], a[204:207], v[16:19], a[48:63]
    ds_read_b128 a[64:67], v63 offset:0
    ds_read_b128 a[68:71], v63 offset:1024
    ds_read_b128 a[72:75], v63 offset:2048
    v_mfma_f32_32x32x16_bf16 v[80:95], a[208:211], v[12:15], v[80:95]
    ds_read_b128 a[76:79], v63 offset:3072
    v_exp_f16_sdwa v45, v45 dst_sel:WORD_0 dst_unused:UNUSED_PRESERVE src0_sel:WORD_0
    v_pk_mul_f16 v46, v23, v46
    v_pk_fma_f16 v47, v24, v24, s60
    v_mfma_f32_32x32x16_bf16 v[80:95], a[212:215], v[16:19], v[80:95]
    v_cvt_pk_f16_f32 v22, v252, v253
    v_rcp_f16_sdwa v42, v42 dst_sel:WORD_1 dst_unused:UNUSED_PRESERVE src0_sel:WORD_1
    v_rcp_f16_sdwa v43, v43 dst_sel:WORD_0 dst_unused:UNUSED_PRESERVE src0_sel:WORD_0
    v_pk_fma_f16 v44, v44, s59, s59
    v_mfma_f32_32x32x16_bf16 v[112:127], a[216:219], v[12:15], v[112:127]
    v_exp_f16_sdwa v45, v45 dst_sel:WORD_1 dst_unused:UNUSED_PRESERVE src0_sel:WORD_1
    s_waitcnt lgkmcnt(3)
    buffer_store_dwordx4 a[64:67], v62, s[32:35], s44 offen offset:0 nt
    v_mfma_f32_32x32x16_bf16 v[112:127], a[220:223], v[16:19], v[112:127]
    v_exp_f16_sdwa v46, v46 dst_sel:WORD_0 dst_unused:UNUSED_PRESERVE src0_sel:WORD_0
    v_pk_mul_f16 v47, v24, v47
    v_pk_fma_f16 v48, v22, v22, s60
    v_cvt_pk_f16_f32 v23, v254, v255
    v_fma_mix_f32 v240, v240, v42, 0 op_sel:[0,0,0] op_sel_hi:[0,1,0]
    v_mfma_f32_32x32x16_bf16 v[144:159], a[224:227], v[12:15], v[144:159]
    s_waitcnt lgkmcnt(2)
    buffer_store_dwordx4 a[68:71], v62, s[32:35], s45 offen offset:0 nt
    v_mfma_f32_32x32x16_bf16 v[144:159], a[228:231], v[16:19], v[144:159]
    v_fma_mix_f32 v241, v241, v42, 0 op_sel:[0,1,0] op_sel_hi:[0,1,0]
    v_rcp_f16_sdwa v43, v43 dst_sel:WORD_1 dst_unused:UNUSED_PRESERVE src0_sel:WORD_1
    v_rcp_f16_sdwa v44, v44 dst_sel:WORD_0 dst_unused:UNUSED_PRESERVE src0_sel:WORD_0
    v_pk_fma_f16 v45, v45, s59, s59
    v_mfma_f32_32x32x16_bf16 v[176:191], a[96:99], v[12:15], v[176:191]
    v_exp_f16_sdwa v46, v46 dst_sel:WORD_1 dst_unused:UNUSED_PRESERVE src0_sel:WORD_1
    s_waitcnt lgkmcnt(1)
    buffer_store_dwordx4 a[72:75], v62, s[32:35], s46 offen offset:0 nt
    v_mfma_f32_32x32x16_bf16 v[176:191], a[100:103], v[16:19], v[176:191]
    v_exp_f16_sdwa v47, v47 dst_sel:WORD_0 dst_unused:UNUSED_PRESERVE src0_sel:WORD_0
    v_pk_mul_f16 v48, v22, v48
    v_pk_fma_f16 v49, v23, v23, s60
    v_cvt_pk_bf16_f32 v34, v240, v241
    v_fma_mix_f32 v242, v242, v43, 0 op_sel:[0,0,0] op_sel_hi:[0,1,0]
    s_waitcnt lgkmcnt(0)
    buffer_store_dwordx4 a[76:79], v62, s[32:35], s47 offen offset:0 nt
    v_fma_mix_f32 v243, v243, v43, 0 op_sel:[0,1,0] op_sel_hi:[0,1,0]
    v_rcp_f16_sdwa v44, v44 dst_sel:WORD_1 dst_unused:UNUSED_PRESERVE src0_sel:WORD_1
    v_rcp_f16_sdwa v45, v45 dst_sel:WORD_0 dst_unused:UNUSED_PRESERVE src0_sel:WORD_0
    v_pk_fma_f16 v46, v46, s59, s59
    v_exp_f16_sdwa v47, v47 dst_sel:WORD_1 dst_unused:UNUSED_PRESERVE src0_sel:WORD_1
    v_exp_f16_sdwa v48, v48 dst_sel:WORD_0 dst_unused:UNUSED_PRESERVE src0_sel:WORD_0
    v_pk_mul_f16 v49, v23, v49
    v_cvt_pk_bf16_f32 v35, v242, v243
    v_fma_mix_f32 v244, v244, v44, 0 op_sel:[0,0,0] op_sel_hi:[0,1,0]
    v_cvt_pk_bf16_f32 v208, v64, v65
    v_cvt_pk_bf16_f32 v209, v66, v67
    v_cvt_pk_bf16_f32 v210, v68, v69
    v_cvt_pk_bf16_f32 v211, v70, v71
    v_cvt_pk_bf16_f32 v212, v72, v73
    v_cvt_pk_bf16_f32 v213, v74, v75
    v_cvt_pk_bf16_f32 v214, v76, v77
    v_cvt_pk_bf16_f32 v215, v78, v79
    ds_write_b128 v25, v[208:211] offset:8192
    ds_write_b128 v56, v[212:215] offset:8192
    v_cvt_pk_bf16_f32 v216, v96, v97
    v_cvt_pk_bf16_f32 v217, v98, v99
    v_cvt_pk_bf16_f32 v218, v100, v101
    v_cvt_pk_bf16_f32 v219, v102, v103
    v_cvt_pk_bf16_f32 v220, v104, v105
    v_cvt_pk_bf16_f32 v221, v106, v107
    v_cvt_pk_bf16_f32 v222, v108, v109
    v_cvt_pk_bf16_f32 v223, v110, v111
    ds_write_b128 v57, v[216:219] offset:8192
    ds_write_b128 v58, v[220:223] offset:8192
    ds_read_b128 a[80:83], v63 offset:8192
    ds_read_b128 a[84:87], v63 offset:9216
    ds_read_b128 a[88:91], v63 offset:10240
    ds_read_b128 a[92:95], v63 offset:11264
    v_fma_mix_f32 v245, v245, v44, 0 op_sel:[0,1,0] op_sel_hi:[0,1,0]
    v_rcp_f16_sdwa v45, v45 dst_sel:WORD_1 dst_unused:UNUSED_PRESERVE src0_sel:WORD_1
    v_rcp_f16_sdwa v46, v46 dst_sel:WORD_0 dst_unused:UNUSED_PRESERVE src0_sel:WORD_0
    v_pk_fma_f16 v47, v47, s59, s59
    v_exp_f16_sdwa v48, v48 dst_sel:WORD_1 dst_unused:UNUSED_PRESERVE src0_sel:WORD_1
    v_exp_f16_sdwa v49, v49 dst_sel:WORD_0 dst_unused:UNUSED_PRESERVE src0_sel:WORD_0
    v_cvt_pk_bf16_f32 v36, v244, v245
    v_fma_mix_f32 v246, v246, v45, 0 op_sel:[0,0,0] op_sel_hi:[0,1,0]
    s_waitcnt lgkmcnt(3)
    buffer_store_dwordx4 a[80:83], v62, s[32:35], s44 offen offset:128 nt
    v_fma_mix_f32 v247, v247, v45, 0 op_sel:[0,1,0] op_sel_hi:[0,1,0]
    v_rcp_f16_sdwa v46, v46 dst_sel:WORD_1 dst_unused:UNUSED_PRESERVE src0_sel:WORD_1
    v_rcp_f16_sdwa v47, v47 dst_sel:WORD_0 dst_unused:UNUSED_PRESERVE src0_sel:WORD_0
    v_pk_fma_f16 v48, v48, s59, s59
    v_exp_f16_sdwa v49, v49 dst_sel:WORD_1 dst_unused:UNUSED_PRESERVE src0_sel:WORD_1
    s_waitcnt lgkmcnt(2)
    buffer_store_dwordx4 a[84:87], v62, s[32:35], s45 offen offset:128 nt
    v_cvt_pk_bf16_f32 v37, v246, v247
    v_fma_mix_f32 v248, v248, v46, 0 op_sel:[0,0,0] op_sel_hi:[0,1,0]
    v_fma_mix_f32 v249, v249, v46, 0 op_sel:[0,1,0] op_sel_hi:[0,1,0]
    v_rcp_f16_sdwa v47, v47 dst_sel:WORD_1 dst_unused:UNUSED_PRESERVE src0_sel:WORD_1
    v_rcp_f16_sdwa v48, v48 dst_sel:WORD_0 dst_unused:UNUSED_PRESERVE src0_sel:WORD_0
    s_waitcnt lgkmcnt(1)
    buffer_store_dwordx4 a[88:91], v62, s[32:35], s46 offen offset:128 nt
    v_pk_fma_f16 v49, v49, s59, s59
    v_cvt_pk_bf16_f32 v38, v248, v249
    v_fma_mix_f32 v250, v250, v47, 0 op_sel:[0,0,0] op_sel_hi:[0,1,0]
    v_fma_mix_f32 v251, v251, v47, 0 op_sel:[0,1,0] op_sel_hi:[0,1,0]
    v_rcp_f16_sdwa v48, v48 dst_sel:WORD_1 dst_unused:UNUSED_PRESERVE src0_sel:WORD_1
    s_waitcnt lgkmcnt(0)
    buffer_store_dwordx4 a[92:95], v62, s[32:35], s47 offen offset:128 nt
    v_rcp_f16_sdwa v49, v49 dst_sel:WORD_0 dst_unused:UNUSED_PRESERVE src0_sel:WORD_0
    v_cvt_pk_bf16_f32 v39, v250, v251
    v_fma_mix_f32 v252, v252, v48, 0 op_sel:[0,0,0] op_sel_hi:[0,1,0]
    v_fma_mix_f32 v253, v253, v48, 0 op_sel:[0,1,0] op_sel_hi:[0,1,0]
    v_rcp_f16_sdwa v49, v49 dst_sel:WORD_1 dst_unused:UNUSED_PRESERVE src0_sel:WORD_1
    v_cvt_pk_bf16_f32 v40, v252, v253
    v_fma_mix_f32 v254, v254, v49, 0 op_sel:[0,0,0] op_sel_hi:[0,1,0]
    v_fma_mix_f32 v255, v255, v49, 0 op_sel:[0,1,0] op_sel_hi:[0,1,0]
    v_cvt_pk_bf16_f32 v41, v254, v255
    v_cvt_pk_bf16_f32 v208, v128, v129
    v_cvt_pk_bf16_f32 v209, v130, v131
    v_mfma_f32_32x32x16_bf16 a[16:31], a[104:107], v[34:37], a[16:31]
    v_cvt_pk_bf16_f32 v210, v132, v133
    v_cvt_pk_bf16_f32 v211, v134, v135
    v_cvt_pk_bf16_f32 v212, v136, v137
    v_cvt_pk_bf16_f32 v213, v138, v139
    v_cvt_pk_bf16_f32 v214, v140, v141
    v_cvt_pk_bf16_f32 v215, v142, v143
    v_mfma_f32_32x32x16_bf16 a[16:31], a[108:111], v[38:41], a[16:31]
    ds_write_b128 v25, v[208:211] offset:16384
    v_mfma_f32_32x32x16_bf16 a[48:63], a[112:115], v[34:37], a[48:63]
    ds_write_b128 v56, v[212:215] offset:16384
    v_cvt_pk_bf16_f32 v216, v160, v161
    v_mfma_f32_32x32x16_bf16 a[48:63], a[116:119], v[38:41], a[48:63]
    v_cvt_pk_bf16_f32 v217, v162, v163
    v_cvt_pk_bf16_f32 v218, v164, v165
    v_cvt_pk_bf16_f32 v219, v166, v167
    v_cvt_pk_bf16_f32 v220, v168, v169
    v_cvt_pk_bf16_f32 v221, v170, v171
    v_cvt_pk_bf16_f32 v222, v172, v173
    v_mfma_f32_32x32x16_bf16 v[80:95], a[120:123], v[34:37], v[80:95]
    v_cvt_pk_bf16_f32 v223, v174, v175
    ds_write_b128 v57, v[216:219] offset:16384
    v_mfma_f32_32x32x16_bf16 v[80:95], a[124:127], v[38:41], v[80:95]
    ds_write_b128 v58, v[220:223] offset:16384
    v_mfma_f32_32x32x16_bf16 v[112:127], a[160:163], v[34:37], v[112:127]
    ds_read_b128 a[64:67], v63 offset:16384
    ds_read_b128 a[68:71], v63 offset:17408
    ds_read_b128 a[72:75], v63 offset:18432
    v_mfma_f32_32x32x16_bf16 v[112:127], a[164:167], v[38:41], v[112:127]
    ds_read_b128 a[76:79], v63 offset:19456
    v_accvgpr_read_b32 v192, a16
    v_accvgpr_read_b32 v193, a17
    v_accvgpr_read_b32 v194, a18
    v_accvgpr_read_b32 v195, a19
    v_mfma_f32_32x32x16_bf16 v[144:159], a[168:171], v[34:37], v[144:159]
    v_accvgpr_read_b32 v196, a20
    v_accvgpr_read_b32 v197, a21
    v_accvgpr_read_b32 v198, a22
    v_accvgpr_read_b32 v199, a23
    s_waitcnt lgkmcnt(3)
    buffer_store_dwordx4 a[64:67], v62, s[32:35], s44 offen offset:256 nt
    v_mfma_f32_32x32x16_bf16 v[144:159], a[172:175], v[38:41], v[144:159]
    v_accvgpr_read_b32 v200, a24
    v_accvgpr_read_b32 v201, a25
    v_accvgpr_read_b32 v202, a26
    v_accvgpr_read_b32 v203, a27
    v_accvgpr_read_b32 v204, a28
    s_waitcnt lgkmcnt(2)
    buffer_store_dwordx4 a[68:71], v62, s[32:35], s45 offen offset:256 nt
    v_mfma_f32_32x32x16_bf16 v[176:191], a[176:179], v[34:37], v[176:191]
    v_accvgpr_read_b32 v205, a29
    v_accvgpr_read_b32 v206, a30
    v_accvgpr_read_b32 v207, a31
    v_cvt_pk_bf16_f32 v208, v192, v193
    v_cvt_pk_bf16_f32 v209, v194, v195
    s_waitcnt lgkmcnt(1)
    buffer_store_dwordx4 a[72:75], v62, s[32:35], s46 offen offset:256 nt
    v_mfma_f32_32x32x16_bf16 v[176:191], a[180:183], v[38:41], v[176:191]
    v_cvt_pk_bf16_f32 v210, v196, v197
    v_cvt_pk_bf16_f32 v211, v198, v199
    v_cvt_pk_bf16_f32 v212, v200, v201
    v_cvt_pk_bf16_f32 v213, v202, v203
    v_cvt_pk_bf16_f32 v214, v204, v205
    s_waitcnt lgkmcnt(0)
    buffer_store_dwordx4 a[76:79], v62, s[32:35], s47 offen offset:256 nt
    v_cvt_pk_bf16_f32 v215, v206, v207
    ds_write_b128 v25, v[208:211] offset:4096
    ds_write_b128 v56, v[212:215] offset:4096
    v_accvgpr_read_b32 v192, a48
    v_accvgpr_read_b32 v193, a49
    v_accvgpr_read_b32 v194, a50
    v_accvgpr_read_b32 v195, a51
    v_accvgpr_read_b32 v196, a52
    v_accvgpr_read_b32 v197, a53
    v_accvgpr_read_b32 v198, a54
    v_accvgpr_read_b32 v199, a55
    v_accvgpr_read_b32 v200, a56
    v_accvgpr_read_b32 v201, a57
    v_accvgpr_read_b32 v202, a58
    v_accvgpr_read_b32 v203, a59
    v_accvgpr_read_b32 v204, a60
    v_accvgpr_read_b32 v205, a61
    v_accvgpr_read_b32 v206, a62
    v_accvgpr_read_b32 v207, a63
    v_cvt_pk_bf16_f32 v216, v192, v193
    v_cvt_pk_bf16_f32 v217, v194, v195
    v_cvt_pk_bf16_f32 v218, v196, v197
    v_cvt_pk_bf16_f32 v219, v198, v199
    v_cvt_pk_bf16_f32 v220, v200, v201
    v_cvt_pk_bf16_f32 v221, v202, v203
    v_cvt_pk_bf16_f32 v222, v204, v205
    v_cvt_pk_bf16_f32 v223, v206, v207
    ds_write_b128 v57, v[216:219] offset:4096
    ds_write_b128 v58, v[220:223] offset:4096
    ds_read_b128 a[80:83], v63 offset:4096
    ds_read_b128 a[84:87], v63 offset:5120
    ds_read_b128 a[88:91], v63 offset:6144
    ds_read_b128 a[92:95], v63 offset:7168
    v_cvt_pk_bf16_f32 v208, v80, v81
    v_cvt_pk_bf16_f32 v209, v82, v83
    v_cvt_pk_bf16_f32 v210, v84, v85
    v_cvt_pk_bf16_f32 v211, v86, v87
    v_cvt_pk_bf16_f32 v212, v88, v89
    v_cvt_pk_bf16_f32 v213, v90, v91
    v_cvt_pk_bf16_f32 v214, v92, v93
    v_cvt_pk_bf16_f32 v215, v94, v95
    s_waitcnt lgkmcnt(3)
    buffer_store_dwordx4 a[80:83], v62, s[32:35], s48 offen offset:0 nt
    ds_write_b128 v25, v[208:211] offset:12288
    ds_write_b128 v56, v[212:215] offset:12288
    v_cvt_pk_bf16_f32 v216, v112, v113
    v_cvt_pk_bf16_f32 v217, v114, v115
    v_cvt_pk_bf16_f32 v218, v116, v117
    s_waitcnt lgkmcnt(4)
    buffer_store_dwordx4 a[84:87], v62, s[32:35], s49 offen offset:0 nt
    v_cvt_pk_bf16_f32 v219, v118, v119
    v_cvt_pk_bf16_f32 v220, v120, v121
    v_cvt_pk_bf16_f32 v221, v122, v123
    v_cvt_pk_bf16_f32 v222, v124, v125
    v_cvt_pk_bf16_f32 v223, v126, v127
    s_waitcnt lgkmcnt(3)
    buffer_store_dwordx4 a[88:91], v62, s[32:35], s50 offen offset:0 nt
    ds_write_b128 v57, v[216:219] offset:12288
    ds_write_b128 v58, v[220:223] offset:12288
    ds_read_b128 a[64:67], v63 offset:12288
    ds_read_b128 a[68:71], v63 offset:13312
    ds_read_b128 a[72:75], v63 offset:14336
    s_waitcnt lgkmcnt(7)
    buffer_store_dwordx4 a[92:95], v62, s[32:35], s51 offen offset:0 nt
    ds_read_b128 a[76:79], v63 offset:15360
    v_cvt_pk_bf16_f32 v208, v144, v145
    v_cvt_pk_bf16_f32 v209, v146, v147
    v_cvt_pk_bf16_f32 v210, v148, v149
    v_cvt_pk_bf16_f32 v211, v150, v151
    v_cvt_pk_bf16_f32 v212, v152, v153
    v_cvt_pk_bf16_f32 v213, v154, v155
    v_cvt_pk_bf16_f32 v214, v156, v157
    v_cvt_pk_bf16_f32 v215, v158, v159
    s_waitcnt lgkmcnt(3)
    buffer_store_dwordx4 a[64:67], v62, s[32:35], s48 offen offset:128 nt
    ds_write_b128 v25, v[208:211] offset:20480
    ds_write_b128 v56, v[212:215] offset:20480
    v_cvt_pk_bf16_f32 v216, v176, v177
    v_cvt_pk_bf16_f32 v217, v178, v179
    v_cvt_pk_bf16_f32 v218, v180, v181
    s_waitcnt lgkmcnt(4)
    buffer_store_dwordx4 a[68:71], v62, s[32:35], s49 offen offset:128 nt
    v_cvt_pk_bf16_f32 v219, v182, v183
    v_cvt_pk_bf16_f32 v220, v184, v185
    v_cvt_pk_bf16_f32 v221, v186, v187
    v_cvt_pk_bf16_f32 v222, v188, v189
    v_cvt_pk_bf16_f32 v223, v190, v191
    s_waitcnt lgkmcnt(3)
    buffer_store_dwordx4 a[72:75], v62, s[32:35], s50 offen offset:128 nt
    ds_write_b128 v57, v[216:219] offset:20480
    ds_write_b128 v58, v[220:223] offset:20480
    ds_read_b128 a[80:83], v63 offset:20480
    ds_read_b128 a[84:87], v63 offset:21504
    ds_read_b128 a[88:91], v63 offset:22528
    s_waitcnt lgkmcnt(7)
    buffer_store_dwordx4 a[76:79], v62, s[32:35], s51 offen offset:128 nt
    ds_read_b128 a[92:95], v63 offset:23552
    s_waitcnt lgkmcnt(3)
    buffer_store_dwordx4 a[80:83], v62, s[32:35], s48 offen offset:256 nt
    s_waitcnt lgkmcnt(2)
    buffer_store_dwordx4 a[84:87], v62, s[32:35], s49 offen offset:256 nt
    s_waitcnt lgkmcnt(1)
    buffer_store_dwordx4 a[88:91], v62, s[32:35], s50 offen offset:256 nt
    s_waitcnt lgkmcnt(0)
    buffer_store_dwordx4 a[92:95], v62, s[32:35], s51 offen offset:256 nt
L_end:
    s_endpgm
L_helper:
    v_lshrrev_b32 v3, 6, v0
    s_nop 0
    v_readfirstlane_b32 s40, v3
    v_and_b32 v3, 63, v0
    v_lshrrev_b32 v12, 5, v3
    v_bfe_u32 v13, v3, 2, 2
    v_lshl_add_u32 v14, v12, 3, v13
    v_lshlrev_b32 v14, 7, v14
    v_bfe_u32 v2, v3, 4, 1
    v_lshl_add_u32 v14, v2, 5, v14
    v_and_b32 v2, 3, v3
    v_lshl_add_u32 v14, v2, 3, v14
    v_bfe_u32 v2, v3, 3, 1
    v_lshl_add_u32 v50, v2, 6, v14
    v_lshrrev_b32 v12, 3, v3
    v_mul_u32_u24 v12, 1536, v12
    v_and_b32 v13, 7, v3
    v_bfe_u32 v14, v3, 4, 1
    v_lshlrev_b32 v14, 2, v14
    v_xor_b32 v13, v13, v14
    v_lshl_add_u32 v56, v13, 4, v12
    v_add_u32 v57, 11264, v56
    v_add_u32 v58, 22528, v56
    v_lshlrev_b32 v59, 4, v3
    v_lshrrev_b32 v12, 5, v3
    v_bfe_u32 v13, v3, 2, 2
    v_lshl_add_u32 v14, v12, 2, v13
    v_mul_u32_u24 v14, 384, v14
    v_bfe_u32 v15, v3, 4, 1
    v_lshl_add_u32 v14, v15, 5, v14
    v_and_b32 v15, 1, v3
    v_lshl_add_u32 v14, v15, 4, v14
    v_bfe_u32 v15, v3, 1, 1
    v_lshl_add_u32 v14, v15, 3, v14
    s_mul_i32 s41, s40, 6144
    v_add_u32 v14, s41, v14
    v_lshl_add_u32 v4, v2, 6, v14
    v_xor_b32 v2, 1, v2
    v_lshl_add_u32 v5, v2, 6, v14
    v_xor_b32 v2, 64, v59
    v_cmp_le_u32 vcc, 48, v3
    v_cmp_gt_u32 s[54:55], 32, v3
    v_cmp_le_u32 s[56:57], 16, v3
    v_cndmask_b32 v6, v59, v2, vcc
    v_cndmask_b32 v7, v59, v2, s[54:55]
    v_cndmask_b32 v8, v59, v2, s[56:57]
    s_lshr_b32 s42, s40, 1
    s_lshl_b32 s42, s42, 6
    s_and_b32 s43, s40, 1
    s_mul_i32 s43, s43, 12288
    v_xor_b32 v50, s42, v50
    v_add_u32 v50, s43, v50
    s_waitcnt lgkmcnt(0)
    s_mov_b32 s84, s80
    s_mov_b32 s85, s81
    s_mov_b32 s86, 2097152
    s_mov_b32 s87, 0x20000
    s_mov_b32 s88, s14
    s_mov_b32 s89, s15
    s_mov_b32 s90, 256
    s_mov_b32 s91, 0x20000
    s_mov_b32 s26, 294912
    s_mov_b32 s27, 0x20000
    s_mul_i32 s44, s2, 24576
    s_add_u32 s44, s44, s41
    s_add_u32 s45, s44, 1048576
    s_add_u32 s46, s45, 3072
    s_mov_b32 m0, s41
    s_cmp_ge_u32 s2, 12
    s_cbranch_scc1 L_help2
    s_mov_b32 s24, s8
    s_mov_b32 s25, s9
    s_mul_i32 s47, s40, 73728
    s_lshl_b32 s48, s2, 7
    s_add_u32 s47, s47, s48
    s_add_u32 s48, s47, 36864
    buffer_load_dwordx4 v56, s[24:27], s47 offen offset:0 lds
    buffer_load_dwordx4 v57, s[24:27], s47 offen offset:1024 lds
    buffer_load_dwordx4 v58, s[24:27], s47 offen offset:2048 lds
    s_add_u32 m0, s41, 3072
    s_nop 0
    buffer_load_dwordx4 v56, s[24:27], s48 offen offset:0 lds
    buffer_load_dwordx4 v57, s[24:27], s48 offen offset:1024 lds
    buffer_load_dwordx4 v58, s[24:27], s48 offen offset:2048 lds
    s_waitcnt vmcnt(0)
    s_barrier
    ds_read_b64_tr_b16 v[64:65], v50 offset:0
    ds_read_b64_tr_b16 v[66:67], v50 offset:512
    ds_read_b64_tr_b16 v[68:69], v50 offset:2048
    ds_read_b64_tr_b16 v[70:71], v50 offset:2560
    ds_read_b64_tr_b16 v[72:73], v50 offset:4096
    ds_read_b64_tr_b16 v[74:75], v50 offset:4608
    ds_read_b64_tr_b16 v[76:77], v50 offset:6144
    ds_read_b64_tr_b16 v[78:79], v50 offset:6656
    ds_read_b64_tr_b16 v[80:81], v50 offset:8192
    ds_read_b64_tr_b16 v[82:83], v50 offset:8704
    ds_read_b64_tr_b16 v[84:85], v50 offset:10240
    ds_read_b64_tr_b16 v[86:87], v50 offset:10752
    s_branch L_help3
L_help2:
    s_mov_b32 s24, s10
    s_mov_b32 s25, s11
    s_sub_u32 s47, s44, 294912
    s_add_u32 s48, s47, 3072
    buffer_load_dwordx4 v6, s[24:27], s47 offen offset:0 lds
    buffer_load_dwordx4 v7, s[24:27], s47 offen offset:1024 lds
    buffer_load_dwordx4 v8, s[24:27], s47 offen offset:2048 lds
    s_add_u32 m0, s41, 3072
    s_nop 0
    buffer_load_dwordx4 v6, s[24:27], s48 offen offset:0 lds
    buffer_load_dwordx4 v7, s[24:27], s48 offen offset:1024 lds
    buffer_load_dwordx4 v8, s[24:27], s48 offen offset:2048 lds
    s_waitcnt vmcnt(0)
    s_barrier
    ds_read_b64_tr_b16 v[64:65], v4 offset:0
    ds_read_b64_tr_b16 v[66:67], v4 offset:3072
    ds_read_b64_tr_b16 v[68:69], v5 offset:0
    ds_read_b64_tr_b16 v[70:71], v5 offset:3072
    ds_read_b64_tr_b16 v[72:73], v4 offset:128
    ds_read_b64_tr_b16 v[74:75], v4 offset:3200
    ds_read_b64_tr_b16 v[76:77], v5 offset:128
    ds_read_b64_tr_b16 v[78:79], v5 offset:3200
    ds_read_b64_tr_b16 v[80:81], v4 offset:256
    ds_read_b64_tr_b16 v[82:83], v4 offset:3328
    ds_read_b64_tr_b16 v[84:85], v5 offset:256
    ds_read_b64_tr_b16 v[86:87], v5 offset:3328
L_help3:
    s_waitcnt lgkmcnt(0)
    buffer_store_dwordx4 v[64:67], v59, s[84:87], s45 offen offset:0 sc1
    buffer_store_dwordx4 v[68:71], v59, s[84:87], s45 offen offset:1024 sc1
    buffer_store_dwordx4 v[72:75], v59, s[84:87], s45 offen offset:2048 sc1
    buffer_store_dwordx4 v[76:79], v59, s[84:87], s46 offen offset:0 sc1
    buffer_store_dwordx4 v[80:83], v59, s[84:87], s46 offen offset:1024 sc1
    buffer_store_dwordx4 v[84:87], v59, s[84:87], s46 offen offset:2048 sc1
    s_waitcnt vmcnt(0)
    s_barrier
    v_mov_b32 v1, 1
    v_cmp_eq_u32 vcc, 0, v0
    s_and_saveexec_b64 s[54:55], vcc
    s_cbranch_execz L_hend
    buffer_atomic_add v1, off, s[88:91], 0 sc1
L_hend:
    s_endpgm
L_code_end:
.section .rodata,"a"
.p2align 6
.amdhsa_kernel standalone__convnext_block__vision_kernel
  .amdhsa_next_free_vgpr 512
  .amdhsa_next_free_sgpr 96
  .amdhsa_accum_offset 256
  .amdhsa_group_segment_fixed_size 0
  .amdhsa_kernarg_size 56
  .amdhsa_user_sgpr_count 2
  .amdhsa_user_sgpr_kernarg_segment_ptr 1
  .amdhsa_system_sgpr_workgroup_id_x 1
.end_amdhsa_kernel
```
